```python
import torch

def _softmax(x, axis=-1):
    return torch.softmax(x, dim=axis)
def _gelu(x):
    return torch.nn.functional.gelu(x, approximate="tanh")
def _silu(x):
    return torch.nn.functional.silu(x)
def _sigmoid(x):
    return torch.sigmoid(x)
def _layernorm(x, axis=-1, eps=1e-5):
    m = x.mean(dim=axis, keepdim=True)
    v = x.var(dim=axis, keepdim=True, unbiased=False)
    return (x - m) / torch.sqrt(v + eps)
def _scatter_add(tgt, idx, src, axis=0):
    return tgt.clone().index_add_(axis, idx, src)
def _segment_sum(src, seg, n):
    out = torch.zeros((n,) + src.shape[1:], dtype=src.dtype)
    return out.index_add_(0, seg, src)
def _pad(x, pw):
    flat = tuple(v for pair in reversed(pw) for v in pair)
    return torch.nn.functional.pad(x, flat)

kernel_name = 'gated_mix__grouped_kv_mqa__sliding_local_dilated__prompt'

def setup_inputs():

    _w = (lambda a: (lambda t: t.to(torch.bfloat16) if t.is_floating_point() else t)(torch.as_tensor(a)))
    def _A_setup():
        B, S, D, H = 1, 2048, 640, 32
        Dh = D // H
        return {
            "x": _w((lambda *s: torch.randn(*s, dtype=torch.bfloat16) * 0.05)(B, S, D)),
            "wq": _w((lambda *s: torch.randn(*s, dtype=torch.bfloat16) * 1.6)(D, H * Dh)),
            "wk": _w((lambda *s: torch.randn(*s, dtype=torch.bfloat16) * 1.6)(D, Dh)),
            "wv": _w((lambda *s: torch.randn(*s, dtype=torch.bfloat16) * 0.2)(D, Dh)),
            "wo": _w((lambda *s: torch.randn(*s, dtype=torch.bfloat16) * 0.2)(H * Dh, D)),
        }
    _A_in = _A_setup()

    def _B_setup():
        B, S, D = 1, 2048, 640
        return {
            "x": _w((lambda *s: torch.randn(*s, dtype=torch.bfloat16) * 0.05)(B, S, D)),
            "wqkv": _w((lambda *s: torch.randn(*s, dtype=torch.bfloat16) * 0.8)(D, 3 * D)),
            "wo": _w((lambda *s: torch.randn(*s, dtype=torch.bfloat16) * 0.05)(D, D)),
        }
    _B_in = _B_setup()

    return {
        "A_x": _A_in["x"],
        "A_wq": _A_in["wq"],
        "A_wk": _A_in["wk"],
        "A_wv": _A_in["wv"],
        "A_wo": _A_in["wo"],
        "B_x": _B_in["x"],
        "B_wqkv": _B_in["wqkv"],
        "B_wo": _B_in["wo"],
        "gate_w": _w((lambda *s: torch.randn(*s, dtype=torch.bfloat16) * 0.05)(640) * 16.0),
    }

def reference(A_x, A_wq, A_wk, A_wv, A_wo, B_x, B_wqkv, B_wo, gate_w):
    def _A_ref(x, wq, wk, wv, wo):
        B, S, D = x.shape
        H = 32
        Dh = D // H
        q = (lambda x, *d: x.permute(*d))((x @ wq).reshape(B, S, H, Dh), 0, 2, 1, 3)
        k = x @ wk
        v = x @ wv
        scores = torch.einsum("bhqd,bkd->bhqk", q, k) * (Dh ** -0.5)
        p = _softmax(scores, axis=-1)
        o = torch.einsum("bhqk,bkd->bhqd", p, v)
        return (lambda x, *d: x.permute(*d))(o, 0, 2, 1, 3).reshape(B, S, H * Dh) @ wo

    def _B_ref(x, wqkv, wo):
        B, S, D = x.shape
        H = 32; Dh = D // H
        W, dil = 8, 2
        qkv = (lambda x, *d: x.permute(*d))((x @ wqkv).reshape(B, S, 3, H, Dh), 2, 0, 3, 1, 4)
        q, k, v = qkv[0], qkv[1], qkv[2]
        scale = Dh ** -0.5
        pos = torch.arange(S)
        off = torch.arange(W) * dil
        idx = pos[:, None] - off[None, :]
        mask = idx >= 0
        idx_c = torch.where(mask, idx, 0).reshape(-1)
        kg = k[:, :, idx_c, :].reshape(B, H, S, W, Dh)
        vg = v[:, :, idx_c, :].reshape(B, H, S, W, Dh)
        logits = torch.einsum("bhsd,bhswd->bhsw", q, kg) * scale
        logits = torch.where(mask[None, None, :, :], logits, -1e9)
        attn = _softmax(logits, axis=-1)
        o = torch.einsum("bhsw,bhswd->bhsd", attn, vg)
        return (lambda x, *d: x.permute(*d))(o, 0, 2, 1, 3).reshape(B, S, D) @ wo

    x = A_x
    g = _sigmoid((x * gate_w).sum(-1, keepdims=True))
    a = _A_ref(x, A_wq, A_wk, A_wv, A_wo)
    b = _B_ref(x, B_wqkv, B_wo)
    return g * a + (1 - g) * b
```

```asm
; @launch grid=(256,1,1) block=(512,1,1) lds=163840
.amdgcn_target "amdgcn-amd-amdhsa--gfx950"
.text
.globl gated_mix__grouped_kv_mqa__sliding_local_dilated__prompt_kernel
.p2align 8
.type gated_mix__grouped_kv_mqa__sliding_local_dilated__prompt_kernel,@function
gated_mix__grouped_kv_mqa__sliding_local_dilated__prompt_kernel:

  s_cmp_ge_u32 s2, 256
  s_cbranch_scc1 F_end
  s_load_dwordx16 s[16:31], s[0:1], 0
  s_load_dwordx8 s[32:39], s[0:1], 64
  v_and_b32 v1, 63, v0
  v_lshrrev_b32 v4, 6, v0
  v_lshrrev_b32 v2, 5, v1
  v_readfirstlane_b32 s9, v4
  v_and_b32 v3, 31, v1
  v_and_b32 v10, 15, v1
  v_lshrrev_b32 v11, 4, v1
  s_and_b32 s3, s2, 7
  s_lshr_b32 s6, s2, 3

  s_cmp_lg_u32 s9, 1
  s_cbranch_scc1 F_nocp
  s_getpc_b64 s[40:41]
  F_pc:
  s_sub_u32 s40, s40, F_pc-gated_mix__grouped_kv_mqa__sliding_local_dilated__prompt_kernel
  s_subb_u32 s41, s41, 0
  s_mov_b32 s42, F_last-gated_mix__grouped_kv_mqa__sliding_local_dilated__prompt_kernel-16
  s_lshl_b32 s3, s6, 11
  v_lshlrev_b32 v4, 4, v1
  v_add_u32 v144, s3, v4
  v_add_u32 v148, 0x400, v144
  v_min_u32 v144, s42, v144
  v_min_u32 v148, s42, v148
  v_mov_b32 v145, s41
  v_mov_b32 v149, s41
  v_add_co_u32 v144, vcc, s40, v144
  v_addc_co_u32 v145, vcc, 0, v145, vcc
  v_add_co_u32 v148, vcc, s40, v148
  v_addc_co_u32 v149, vcc, 0, v149, vcc
  global_load_dwordx4 v[144:147], v[144:145], off
  global_load_dwordx4 v[148:151], v[148:149], off

  s_and_b32 s3, s2, 7
F_nocp:
  s_lshr_b32 s4, s3, 1
  s_lshl_b32 s4, s4, 3
  s_lshr_b32 s5, s6, 2
  s_add_u32 s7, s4, s5

  s_and_b32 s3, s3, 1
  s_lshl_b32 s3, s3, 2
  s_and_b32 s60, s6, 3
  s_add_u32 s8, s3, s60
  s_cmp_ge_u32 s5, 5
  s_cselect_b32 s3, 5, 0
  s_sub_u32 s61, s5, s3
  s_sub_u32 s96, s8, s5
  s_and_b32 s96, s96, 3

  s_and_b32 s3, s8, 4
  s_or_b32 s96, s96, s3
  s_and_b32 s10, s9, 1
  s_cmp_ge_u32 s9, 4
  s_cbranch_scc1 F_hi
  s_cmp_lt_u32 s9, 2
  s_cbranch_scc1 F_lo

  s_lshl_b32 s3, s7, 6
  s_lshl_b32 s4, s10, 4
  s_add_u32 s3, s3, s4
  v_lshrrev_b32 v4, 3, v1
  v_and_b32 v5, 7, v1
  v_xor_b32 v7, v11, v5
  v_add_u32 v6, s3, v4
  v_mul_u32_u24 v6, 1280, v6
  v_lshl_add_u32 v16, v7, 4, v6
  v_xor_b32 v7, 4, v7
  v_lshl_add_u32 v17, v7, 4, v6
  v_add_u32 v17, 10240, v17
  s_lshl_b32 s11, s10, 10
  v_lshlrev_b32 v18, 4, v1
  s_and_b32 s3, s96, 1
  s_mul_i32 s13, s3, 40960
  s_lshl_b32 s12, s3, 12
  s_lshl_b32 s4, s10, 11
  s_add_u32 s12, s12, s4
  s_lshl_b32 s3, s10, 2
  s_add_u32 s3, s3, 161792
  v_mov_b32 v22, s3
  s_waitcnt lgkmcnt(0)

  s_mov_b32 s40, s16
  s_mov_b32 s41, s17
  s_mov_b32 s42, 2621440
  s_mov_b32 s43, 0x20000
  s_branch F_xmain
F_eissue:
  s_mul_i32 s14, s60, 5120
  s_add_u32 s4, s14, s11
  s_add_u32 m0, s4, 122880
  s_add_u32 s14, s14, 4096
  buffer_load_dwordx4 v18, s[52:55], s4 offen lds
  buffer_load_dwordx4 v18, s[52:55], s4 offen offset:2048 lds
  s_add_u32 m0, s14, 122880
  s_nop 0
  buffer_load_dwordx4 v18, s[52:55], s14 offen lds

F_xissue:
  s_lshl_b32 s14, s60, 8
  s_add_u32 s14, s14, s13
  s_lshl_b32 s15, s60, 14
  s_add_u32 s15, s15, s12

  s_add_u32 m0, s15, 0
  s_add_u32 s4, s14, 0
  buffer_load_dwordx4 v16, s[40:43], s4 offen lds
  s_add_u32 m0, s15, 1024
  s_add_u32 s4, s14, 0
  buffer_load_dwordx4 v17, s[40:43], s4 offen lds
  s_add_u32 m0, s15, 8192
  s_add_u32 s4, s14, 128
  buffer_load_dwordx4 v16, s[40:43], s4 offen lds
  s_add_u32 m0, s15, 9216
  s_add_u32 s4, s14, 128
  buffer_load_dwordx4 v17, s[40:43], s4 offen lds
  s_add_u32 s60, s60, 1
  s_cmp_eq_u32 s60, 5
  s_cselect_b32 s60, 0, s60
  s_setpc_b64 s[98:99]

F_xmain:
  s_cmp_ge_u32 s96, 4
  s_cbranch_scc1 F_noex
  s_cmp_lt_u32 s96, 2
  s_cselect_b32 s52, s20, s22
  s_cselect_b32 s53, s21, s23
  s_mov_b32 s54, 25600
  s_mov_b32 s55, 0x20000

  s_call_b64 s[98:99], F_eissue
  s_barrier
  s_call_b64 s[98:99], F_eissue
  s_call_b64 s[98:99], F_eissue
  s_call_b64 s[98:99], F_eissue
  v_mov_b32 v23, 1
  s_waitcnt vmcnt(21)
  ds_write_b32 v22, v23
  s_call_b64 s[98:99], F_eissue
  s_xor_b32 s13, s13, 40960
  s_xor_b32 s12, s12, 4096

  v_mov_b32 v23, 2
  s_waitcnt vmcnt(21)
  ds_write_b32 v22, v23
  s_call_b64 s[98:99], F_xissue
  v_mov_b32 v23, 3
  s_waitcnt vmcnt(18)
  ds_write_b32 v22, v23
  s_call_b64 s[98:99], F_xissue
  v_mov_b32 v23, 4
  s_waitcnt vmcnt(15)
  ds_write_b32 v22, v23
  s_call_b64 s[98:99], F_xissue
  v_mov_b32 v23, 5
  s_waitcnt vmcnt(12)
  ds_write_b32 v22, v23
  s_call_b64 s[98:99], F_xissue
  s_call_b64 s[98:99], F_xissue
  s_branch F_xdone
F_noex:
  s_cmp_lg_u32 s96, 4
  s_cbranch_scc1 F_nog

  s_mov_b32 s52, s32
  s_mov_b32 s53, s33
  s_mov_b32 s54, 1280
  s_mov_b32 s55, 0x20000
  s_add_u32 m0, s11, 162048
  s_cmp_eq_u32 s10, 0
  s_cselect_b32 exec_lo, -1, 0xffff
  s_cselect_b32 exec_hi, -1, 0
  buffer_load_dwordx4 v18, s[52:55], s11 offen lds
  s_mov_b64 exec, -1

F_nog:
  s_call_b64 s[98:99], F_xissue
  s_barrier
  s_call_b64 s[98:99], F_xissue
  s_call_b64 s[98:99], F_xissue
  s_call_b64 s[98:99], F_xissue
  s_call_b64 s[98:99], F_xissue
  s_xor_b32 s13, s13, 40960
  s_xor_b32 s12, s12, 4096

  s_call_b64 s[98:99], F_xissue
  s_call_b64 s[98:99], F_xissue
  s_call_b64 s[98:99], F_xissue
  s_call_b64 s[98:99], F_xissue
  s_call_b64 s[98:99], F_xissue
  v_mov_b32 v23, 5
  ds_write_b32 v22, v23
F_xdone:
  v_mov_b32 v23, 10
  s_waitcnt vmcnt(0)
  ds_write_b32 v22, v23
  s_branch F_work
F_hi:
  s_barrier
  s_waitcnt lgkmcnt(0)

  s_call_b64 s[98:99], F_hsetup
  s_cmp_ge_u32 s9, 6
  s_cbranch_scc1 F_wload

  s_cmp_lg_u32 s9, 5
  s_cbranch_scc1 F_n6
  s_mov_b32 s56, s36
  s_mov_b32 s57, s37
  s_mov_b32 s58, 256
  s_mov_b32 s59, 0x20000
  v_mov_b32 v5, 0
  s_mov_b32 s4, 0
F_n4:
  buffer_load_dwordx2 v[6:7], v5, s[56:59], 0 offen sc1
  s_add_u32 s4, s4, 1
  s_waitcnt vmcnt(0)
  v_readfirstlane_b32 s3, v6
  s_cmp_lg_u32 s3, 0
  s_cbranch_scc1 F_n5
  s_sleep 4
  s_cmp_lt_u32 s4, 200000
  s_cbranch_scc1 F_n4

F_n5:
  v_mov_b32 v4, 161792
  ds_write_b64 v4, v[6:7] offset:40
F_n6:
  s_cmp_eq_u32 s96, 4
  s_cbranch_scc1 F_extra
  s_cmp_gt_u32 s96, 4
  s_cbranch_scc1 F_hpre2
  s_cmp_eq_u32 s9, 5
  s_cbranch_scc1 F_hpre2
  s_branch F_extra

F_wload:
  s_mul_i32 s3, s8, 160
  v_add_u32 v4, 0, v1
  v_mul_u32_u24 v5, 6554, v4
  v_lshrrev_b32 v5, 16, v5
  v_mul_u32_u24 v6, 160, v5
  v_lshlrev_b32 v4, 4, v4
  v_sub_u32 v4, v4, v6
  v_bfe_u32 v6, v5, 1, 2
  v_and_b32 v7, 1, v5
  v_lshl_add_u32 v6, v7, 2, v6
  v_and_b32 v5, 24, v5
  v_add_u32 v5, v5, v6
  v_mul_u32_u24 v5, 1280, v5
  v_add3_u32 v24, v5, v4, s3

  v_add_u32 v4, 64, v1
  v_mul_u32_u24 v5, 6554, v4
  v_lshrrev_b32 v5, 16, v5
  v_mul_u32_u24 v6, 160, v5
  v_lshlrev_b32 v4, 4, v4
  v_sub_u32 v4, v4, v6
  v_bfe_u32 v6, v5, 1, 2
  v_and_b32 v7, 1, v5
  v_lshl_add_u32 v6, v7, 2, v6
  v_and_b32 v5, 24, v5
  v_add_u32 v5, v5, v6
  v_mul_u32_u24 v5, 1280, v5
  v_add3_u32 v25, v5, v4, s3

  v_add_u32 v4, 128, v1
  v_mul_u32_u24 v5, 6554, v4
  v_lshrrev_b32 v5, 16, v5
  v_mul_u32_u24 v6, 160, v5
  v_lshlrev_b32 v4, 4, v4
  v_sub_u32 v4, v4, v6
  v_bfe_u32 v6, v5, 1, 2
  v_and_b32 v7, 1, v5
  v_lshl_add_u32 v6, v7, 2, v6
  v_and_b32 v5, 24, v5
  v_add_u32 v5, v5, v6
  v_mul_u32_u24 v5, 1280, v5
  v_add3_u32 v26, v5, v4, s3

  v_add_u32 v4, 192, v1
  v_mul_u32_u24 v5, 6554, v4
  v_lshrrev_b32 v5, 16, v5
  v_mul_u32_u24 v6, 160, v5
  v_lshlrev_b32 v4, 4, v4
  v_sub_u32 v4, v4, v6
  v_bfe_u32 v6, v5, 1, 2
  v_and_b32 v7, 1, v5
  v_lshl_add_u32 v6, v7, 2, v6
  v_and_b32 v5, 24, v5
  v_add_u32 v5, v5, v6
  v_mul_u32_u24 v5, 1280, v5
  v_add3_u32 v27, v5, v4, s3

  v_add_u32 v4, 256, v1
  v_mul_u32_u24 v5, 6554, v4
  v_lshrrev_b32 v5, 16, v5
  v_mul_u32_u24 v6, 160, v5
  v_lshlrev_b32 v4, 4, v4
  v_sub_u32 v4, v4, v6
  v_bfe_u32 v6, v5, 1, 2
  v_and_b32 v7, 1, v5
  v_lshl_add_u32 v6, v7, 2, v6
  v_and_b32 v5, 24, v5
  v_add_u32 v5, v5, v6
  v_mul_u32_u24 v5, 1280, v5
  v_add3_u32 v28, v5, v4, s3

  s_mov_b32 s44, s18
  s_mov_b32 s45, s19
  s_mov_b32 s46, 819200
  s_mov_b32 s47, 0x20000
  s_lshl_b32 s3, s10, 2
  s_add_u32 s3, s3, 161800
  v_mov_b32 v22, s3
  s_mul_i32 s11, s10, 81920
  s_mul_i32 s13, s10, 10240

  s_call_b64 s[98:99], F_hsetup2
  v_mov_b32 v5, 161792
  s_mov_b32 s4, 0
F_l1:
  ds_read_b32 v4, v5 offset:0
  s_add_u32 s4, s4, 1
  s_waitcnt lgkmcnt(0)
  v_readfirstlane_b32 s3, v4
  s_cmp_ge_u32 s3, 5
  s_cbranch_scc1 F_l1_ok

  s_sleep 1
  s_cmp_lt_u32 s4, 1600000
  s_cbranch_scc1 F_l1

F_l1_ok:
  s_mov_b32 s15, 81920
  s_call_b64 s[98:99], F_wissue
F_w0b:
  s_mov_b32 s15, 102400
  s_call_b64 s[98:99], F_wissue
  v_mov_b32 v23, 1
  s_waitcnt vmcnt(10)
  ds_write_b32 v22, v23
  s_cmp_ge_u32 s96, 4
  s_cbranch_scc1 F_nof
  v_mov_b32 v5, 161792
  s_mov_b32 s4, 0
F_l2:
  ds_read_b32 v4, v5 offset:56
  s_add_u32 s4, s4, 1
  s_waitcnt lgkmcnt(0)
  v_readfirstlane_b32 s3, v4
  s_cmp_ge_u32 s3, 1
  s_cbranch_scc1 F_l2_ok

  s_sleep 1
  s_cmp_lt_u32 s4, 1600000
  s_cbranch_scc1 F_l2

F_l2_ok:
F_nof:
  s_mov_b32 s15, 122880
  s_call_b64 s[98:99], F_wissue
F_nof2:
  v_mov_b32 v23, 2
  s_waitcnt vmcnt(10)
  ds_write_b32 v22, v23
  s_cmp_eq_u32 s10, 0
  s_cselect_b32 s3, 104, 0
  s_add_u32 s3, s3, 161808
  v_mov_b32 v5, s3

  s_mov_b32 s4, 0
F_wq3:
  ds_read_b32 v4, v5 offset:0
  s_add_u32 s4, s4, 1
  s_waitcnt lgkmcnt(0)
  v_readfirstlane_b32 s3, v4
  s_cmp_ge_u32 s3, 4
  s_cbranch_scc1 F_wq3_ok
  s_cmp_lt_u32 s4, 1600000
  s_cbranch_scc1 F_wq3

F_wq3_ok:
  s_mov_b32 s15, 81920
  s_call_b64 s[98:99], F_wissue
  v_mov_b32 v23, 3
  s_waitcnt vmcnt(10)
  ds_write_b32 v22, v23
  s_mov_b32 s4, 0
F_wq4:
  ds_read_b32 v4, v5 offset:4
  s_add_u32 s4, s4, 1
  s_waitcnt lgkmcnt(0)
  v_readfirstlane_b32 s3, v4
  s_cmp_ge_u32 s3, 4
  s_cbranch_scc1 F_wq4_ok
  s_cmp_lt_u32 s4, 1600000
  s_cbranch_scc1 F_wq4

F_wq4_ok:
  s_mov_b32 s15, 102400
  s_call_b64 s[98:99], F_wissue
  v_mov_b32 v23, 4
  s_waitcnt vmcnt(10)
  ds_write_b32 v22, v23
  v_mov_b32 v23, 5
  s_waitcnt vmcnt(0)
  ds_write_b32 v22, v23
  s_branch F_hpre
F_wissue:
  s_mul_i32 s14, s61, 163840
  s_add_u32 s14, s14, s11
  s_add_u32 s15, s15, s13

  s_add_u32 m0, s15, 0
  s_nop 0
  buffer_load_dwordx4 v24, s[44:47], s14 offen lds
  s_add_u32 m0, s15, 1024
  s_nop 0
  buffer_load_dwordx4 v25, s[44:47], s14 offen lds
  s_add_u32 m0, s15, 2048
  s_nop 0
  buffer_load_dwordx4 v26, s[44:47], s14 offen lds
  s_add_u32 m0, s15, 3072
  s_nop 0
  buffer_load_dwordx4 v27, s[44:47], s14 offen lds
  s_add_u32 m0, s15, 4096
  s_nop 0
  buffer_load_dwordx4 v28, s[44:47], s14 offen lds
  s_add_u32 m0, s15, 5120
  s_add_u32 s14, s14, 40960
  buffer_load_dwordx4 v24, s[44:47], s14 offen lds
  s_add_u32 m0, s15, 6144
  s_nop 0
  buffer_load_dwordx4 v25, s[44:47], s14 offen lds
  s_add_u32 m0, s15, 7168
  s_nop 0
  buffer_load_dwordx4 v26, s[44:47], s14 offen lds
  s_add_u32 m0, s15, 8192
  s_nop 0
  buffer_load_dwordx4 v27, s[44:47], s14 offen lds
  s_add_u32 m0, s15, 9216
  s_nop 0
  buffer_load_dwordx4 v28, s[44:47], s14 offen lds
  s_add_u32 s61, s61, 1
  s_cmp_eq_u32 s61, 5
  s_cselect_b32 s61, 0, s61
  s_setpc_b64 s[98:99]

F_lo:
  s_cmp_lg_u32 s9, 0
  s_cbranch_scc1 F_notpoll
  v_lshlrev_b32 v4, 2, v1
  v_add_u32 v4, 161792, v4
  v_mov_b32 v5, 0
  ds_write_b32 v4, v5
  s_waitcnt lgkmcnt(0)

  s_mov_b32 s56, s36
  s_mov_b32 s57, s37
  s_mov_b32 s58, 256
  s_mov_b32 s59, 0x20000
  s_cmp_lg_u32 s2, 0
  s_cbranch_scc1 F_n1
  s_memrealtime s[62:63]
  s_waitcnt lgkmcnt(0)
  s_or_b32 s62, s62, 1
  v_mov_b32 v6, s62
  v_mov_b32 v7, s63
  s_mov_b64 exec, 1
  buffer_store_dwordx2 v[6:7], v5, s[56:59], 0 offen sc1
  s_mov_b64 exec, -1
  s_barrier
  s_branch F_n2

F_n1:
  s_barrier
  s_branch F_work
F_n2:
  v_mov_b32 v4, 161792
  ds_write_b64 v4, v[6:7] offset:40

  s_branch F_work
F_notpoll:
  s_barrier

F_work:
  v_lshrrev_b32 v4, 1, v3
  v_and_b32 v4, 7, v4
  v_xor_b32 v4, v4, v2
  v_lshlrev_b32 v5, 7, v3

  v_xor_b32 v6, 0, v4
  v_lshl_add_u32 v90, v6, 4, v5
  v_xor_b32 v6, 2, v4
  v_lshl_add_u32 v91, v6, 4, v5
  v_xor_b32 v6, 4, v4
  v_lshl_add_u32 v92, v6, 4, v5
  v_xor_b32 v6, 6, v4
  v_lshl_add_u32 v93, v6, 4, v5
  v_bfe_u32 v4, v1, 2, 2
  v_lshl_add_u32 v106, v2, 3, v4
  v_and_b32 v5, 3, v1
  v_bfe_u32 v6, v1, 4, 1
  v_lshl_add_u32 v5, v6, 2, v5
  v_min_u32 v5, 4, v5
  v_lshlrev_b32 v107, 3, v5
  v_mov_b32 v22, 161792
  v_mov_b32 v23, 1

  v_mov_b64 v[24:25], 0
  v_mov_b64 v[26:27], 0
  v_mov_b64 v[28:29], 0
  v_mov_b64 v[30:31], 0
  v_mov_b64 v[32:33], 0
  v_mov_b64 v[34:35], 0
  v_mov_b64 v[36:37], 0
  v_mov_b64 v[38:39], 0
  s_waitcnt lgkmcnt(0)
  s_mov_b32 s48, s38
  s_mov_b32 s49, s39
  s_mov_b32 s50, 14024704
  s_mov_b32 s51, 0x20000
  s_mov_b32 s5, 0
  s_mov_b32 s10, 0

  s_mov_b32 s44, s38
  s_mov_b32 s45, s39
  s_mov_b32 s46, 14024704
  s_mov_b32 s47, 0x20000
  ds_read_b64 v[88:89], v22
  v_bfe_u32 v4, v1, 2, 2
  v_add_u32 v4, v4, v106
  v_mul_u32_u24 v4, 160, v4
  s_setprio 2
  s_and_b32 s10, s9, 1
  s_lshr_b32 s11, s9, 1
  s_mul_i32 s3, s11, 80
  v_add3_u32 v20, v4, v107, s3
  v_lshlrev_b32 v12, 4, v1
  v_lshlrev_b32 v13, 3, v1
  v_min_u32 v13, 256, v13
  v_mul_u32_u24 v14, 336, v2
  v_lshl_add_u32 v14, v3, 4, v14
  v_mov_b32 v7, 0x7fffff00
  v_cmp_gt_u32 vcc, 21, v3
  s_mul_i32 s12, s11, 90112
  s_add_u32 s12, s12, 7864320
  v_cndmask_b32 v14, v7, v14, vcc
  s_add_u32 s13, s12, 90112
  s_mul_i32 s14, s6, 2816
  s_add_u32 s14, s14, s12
  s_mov_b32 s15, 7864320
  s_lshl_b32 s3, s9, 12
  s_add_u32 s3, s3, 81920
  v_add_u32 v4, s3, v12
  v_xor_b32 v5, 8192, v4
  s_lshl_b32 s3, s9, 2
  s_add_u32 s3, s3, 161920
  v_mov_b32 v6, s3
  s_xor_b32 s3, s96, s10
  s_and_b32 s3, s3, 5
  s_cselect_b32 s18, 10, 5
  s_lshl_b32 s19, s10, 12
  v_add_u32 v21, 81920, v20
  s_waitcnt vmcnt(0)

  s_lshl_b32 s3, s7, 1
  s_add_u32 s20, s3, s10
  s_xor_b32 s3, s9, 2
  s_mul_i32 s3, s3, 6144
  s_add_u32 s29, s3, 51200
  s_mul_i32 s3, s9, 6144
  s_add_u32 s30, s3, 51200
  s_lshl_b32 s3, s10, 7
  s_add_u32 s3, s3, 163328
  v_lshlrev_b32 v15, 2, v3
  v_add_u32 v15, s3, v15
  s_lshl_b32 s3, s9, 2
  s_add_u32 s31, s3, 161888
  s_mul_i32 s36, s20, 81920
  s_mul_i32 s3, s8, 5120
  s_add_u32 s36, s36, s3
  s_add_u32 s36, s36, 8257536
  s_xor_b32 s4, s11, 1
  s_lshl_b32 s3, s4, 11
  s_add_u32 s37, s36, s3
  s_lshl_b32 s3, s4, 9
  s_add_u32 s40, s36, s3
  s_add_u32 s40, s40, 4096
  s_mov_b32 s42, 0x71800000

  v_mov_b64 v[40:41], 0
  v_mov_b64 v[42:43], 0
  v_mov_b64 v[44:45], 0
  v_mov_b64 v[46:47], 0
  v_mov_b64 v[48:49], 0
  v_mov_b64 v[50:51], 0
  v_mov_b64 v[52:53], 0
  v_mov_b64 v[54:55], 0
  s_waitcnt lgkmcnt(0)
F_qwx:
  v_readfirstlane_b32 s3, v88
  v_readfirstlane_b32 s4, v89
  s_min_u32 s3, s3, s4
  s_cmp_ge_u32 s3, s18
  s_cbranch_scc1 F_qwx_go

  ds_read_b64 v[88:89], v22 offset:0
  s_add_u32 s5, s5, 1
  s_cmp_lt_u32 s5, 1600000
  s_waitcnt lgkmcnt(0)
  s_cbranch_scc1 F_qwx

F_qwx_go:
  s_lshl_b32 s3, s61, 14
  s_add_u32 s3, s3, s19
  s_add_u32 s61, s61, 1
  s_cmp_eq_u32 s61, 5
  s_cselect_b32 s61, 0, s61

  v_add_u32 v16, s3, v90
  v_add_u32 v17, s3, v91
  v_add_u32 v18, s3, v92
  v_add_u32 v19, s3, v93
  ds_read_b128 v[240:243], v16 offset:0
  ds_read_b128 v[244:247], v17 offset:0
  ds_read_b128 v[248:251], v18 offset:0
  ds_read_b128 v[252:255], v19 offset:0
  ds_read_b128 v[144:147], v16 offset:8192
  ds_read_b128 v[148:151], v17 offset:8192
  ds_read_b128 v[152:155], v18 offset:8192
  ds_read_b128 v[156:159], v19 offset:8192
  s_lshl_b32 s3, s61, 14
  s_add_u32 s3, s3, s19
  s_add_u32 s61, s61, 1
  s_cmp_eq_u32 s61, 5
  s_cselect_b32 s61, 0, s61

  v_add_u32 v16, s3, v90
  v_add_u32 v17, s3, v91
  v_add_u32 v18, s3, v92
  v_add_u32 v19, s3, v93
  ds_read_b128 v[160:163], v16 offset:0
  ds_read_b128 v[164:167], v17 offset:0
  ds_read_b128 v[168:171], v18 offset:0
  ds_read_b128 v[96:99], v19 offset:0
  ds_read_b128 v[100:103], v16 offset:8192
  ds_read_b128 v[104:107], v17 offset:8192
  ds_read_b128 v[108:111], v18 offset:8192
  ds_read_b128 v[112:115], v19 offset:8192
  s_lshl_b32 s3, s61, 14
  s_add_u32 s3, s3, s19
  s_add_u32 s61, s61, 1
  s_cmp_eq_u32 s61, 5
  s_cselect_b32 s61, 0, s61

  v_add_u32 v16, s3, v90
  v_add_u32 v17, s3, v91
  v_add_u32 v18, s3, v92
  v_add_u32 v19, s3, v93
  ds_read_b128 v[116:119], v16 offset:0
  ds_read_b128 v[120:123], v17 offset:0
  ds_read_b128 v[124:127], v18 offset:0
  ds_read_b128 v[128:131], v19 offset:0
  ds_read_b128 v[132:135], v16 offset:8192
  ds_read_b128 v[136:139], v17 offset:8192
  ds_read_b128 v[140:143], v18 offset:8192
  ds_read_b128 v[172:175], v19 offset:8192
  s_lshl_b32 s3, s61, 14
  s_add_u32 s3, s3, s19
  s_add_u32 s61, s61, 1
  s_cmp_eq_u32 s61, 5
  s_cselect_b32 s61, 0, s61

  v_add_u32 v16, s3, v90
  v_add_u32 v17, s3, v91
  v_add_u32 v18, s3, v92
  v_add_u32 v19, s3, v93
  ds_read_b128 v[176:179], v16 offset:0
  ds_read_b128 v[180:183], v17 offset:0
  ds_read_b128 v[184:187], v18 offset:0
  ds_read_b128 v[188:191], v19 offset:0
  ds_read_b128 v[192:195], v16 offset:8192
  ds_read_b128 v[196:199], v17 offset:8192
  ds_read_b128 v[200:203], v18 offset:8192
  ds_read_b128 v[204:207], v19 offset:8192
  s_lshl_b32 s3, s61, 14
  s_add_u32 s3, s3, s19
  s_add_u32 s61, s61, 1
  s_cmp_eq_u32 s61, 5
  s_cselect_b32 s61, 0, s61

  v_add_u32 v16, s3, v90
  v_add_u32 v17, s3, v91
  v_add_u32 v18, s3, v92
  v_add_u32 v19, s3, v93
  ds_read_b128 v[208:211], v16 offset:0
  ds_read_b128 v[212:215], v17 offset:0
  ds_read_b128 v[216:219], v18 offset:0
  ds_read_b128 v[220:223], v19 offset:0
  ds_read_b128 v[224:227], v16 offset:8192
  ds_read_b128 v[228:231], v17 offset:8192
  ds_read_b128 v[232:235], v18 offset:8192
  ds_read_b128 v[236:239], v19 offset:8192
  ds_read_b64 v[88:89], v22 offset:8
  s_waitcnt lgkmcnt(0)
F_qw0:
  v_readfirstlane_b32 s3, v88
  s_cmp_ge_u32 s3, 1
  s_cbranch_scc1 F_qw0_go

  ds_read_b32 v88, v22 offset:8
  s_add_u32 s5, s5, 1
  s_cmp_lt_u32 s5, 1600000
  s_waitcnt lgkmcnt(0)
  s_cbranch_scc1 F_qw0

F_qw0_go:
  ds_read_b32 v89, v22 offset:12
  ds_read_b64_tr_b16 v[56:57], v21 offset:0
  ds_read_b64_tr_b16 v[58:59], v21 offset:160
  ds_read_b64_tr_b16 v[60:61], v21 offset:40
  ds_read_b64_tr_b16 v[62:63], v21 offset:200
  ds_read_b64_tr_b16 v[64:65], v21 offset:2560
  ds_read_b64_tr_b16 v[66:67], v21 offset:2720
  ds_read_b64_tr_b16 v[68:69], v21 offset:2600
  ds_read_b64_tr_b16 v[70:71], v21 offset:2760
  ds_read_b64_tr_b16 v[72:73], v21 offset:5120
  ds_read_b64_tr_b16 v[74:75], v21 offset:5280
  ds_read_b64_tr_b16 v[76:77], v21 offset:5160
  ds_read_b64_tr_b16 v[78:79], v21 offset:5320
  ds_read_b64_tr_b16 v[80:81], v21 offset:7680
  ds_read_b64_tr_b16 v[82:83], v21 offset:7840
  ds_read_b64_tr_b16 v[84:85], v21 offset:7720
  ds_read_b64_tr_b16 v[86:87], v21 offset:7880
  s_mov_b64 exec, 1
  ds_add_u32 v22, v23 offset:120
  s_mov_b64 exec, -1
  s_waitcnt lgkmcnt(13)
  v_mfma_f32_32x32x16_bf16 v[24:39], v[56:59], v[240:243], v[24:39]
  v_mfma_f32_32x32x16_bf16 v[40:55], v[60:63], v[240:243], v[40:55]
F_qv0:
  v_readfirstlane_b32 s3, v89
  s_cmp_ge_u32 s3, 1
  s_cbranch_scc1 F_qv0_go

  ds_read_b32 v89, v22 offset:12
  s_add_u32 s5, s5, 1
  s_cmp_lt_u32 s5, 1600000
  s_waitcnt lgkmcnt(0)
  s_cbranch_scc1 F_qv0

F_qv0_go:
  ds_read_b64_tr_b16 v[56:57], v21 offset:10240
  ds_read_b64_tr_b16 v[58:59], v21 offset:10400
  ds_read_b64_tr_b16 v[60:61], v21 offset:10280
  ds_read_b64_tr_b16 v[62:63], v21 offset:10440
  s_waitcnt lgkmcnt(13)
  v_mfma_f32_32x32x16_bf16 v[24:39], v[64:67], v[244:247], v[24:39]
  v_mfma_f32_32x32x16_bf16 v[40:55], v[68:71], v[244:247], v[40:55]
  ds_read_b64_tr_b16 v[64:65], v21 offset:12800
  ds_read_b64_tr_b16 v[66:67], v21 offset:12960
  ds_read_b64_tr_b16 v[68:69], v21 offset:12840
  ds_read_b64_tr_b16 v[70:71], v21 offset:13000
  s_waitcnt lgkmcnt(13)
  v_mfma_f32_32x32x16_bf16 v[24:39], v[72:75], v[248:251], v[24:39]
  v_mfma_f32_32x32x16_bf16 v[40:55], v[76:79], v[248:251], v[40:55]
  ds_read_b32 v88, v22 offset:8
  ds_read_b64_tr_b16 v[72:73], v21 offset:15360
  ds_read_b64_tr_b16 v[74:75], v21 offset:15520
  ds_read_b64_tr_b16 v[76:77], v21 offset:15400
  ds_read_b64_tr_b16 v[78:79], v21 offset:15560
  s_waitcnt lgkmcnt(14)
  v_mfma_f32_32x32x16_bf16 v[24:39], v[80:83], v[252:255], v[24:39]
  v_mfma_f32_32x32x16_bf16 v[40:55], v[84:87], v[252:255], v[40:55]
  ds_read_b64_tr_b16 v[80:81], v21 offset:17920
  ds_read_b64_tr_b16 v[82:83], v21 offset:18080
  ds_read_b64_tr_b16 v[84:85], v21 offset:17960
  ds_read_b64_tr_b16 v[86:87], v21 offset:18120
  s_mov_b64 exec, 1
  ds_add_u32 v22, v23 offset:16
  s_mov_b64 exec, -1
  s_waitcnt lgkmcnt(14)
  v_mfma_f32_32x32x16_bf16 v[24:39], v[56:59], v[144:147], v[24:39]
  v_mfma_f32_32x32x16_bf16 v[40:55], v[60:63], v[144:147], v[40:55]
  s_waitcnt lgkmcnt(9)
F_qw1:
  v_readfirstlane_b32 s3, v88
  s_cmp_ge_u32 s3, 2
  s_cbranch_scc1 F_qw1_go

  ds_read_b32 v88, v22 offset:8
  s_add_u32 s5, s5, 1
  s_cmp_lt_u32 s5, 1600000
  s_waitcnt lgkmcnt(0)
  s_cbranch_scc1 F_qw1

F_qw1_go:
  v_add_u32 v21, 102400, v20
  ds_read_b64_tr_b16 v[56:57], v21 offset:0
  ds_read_b64_tr_b16 v[58:59], v21 offset:160
  ds_read_b64_tr_b16 v[60:61], v21 offset:40
  ds_read_b64_tr_b16 v[62:63], v21 offset:200
  v_mfma_f32_32x32x16_bf16 v[24:39], v[64:67], v[148:151], v[24:39]
  v_mfma_f32_32x32x16_bf16 v[40:55], v[68:71], v[148:151], v[40:55]
  ds_read_b64_tr_b16 v[64:65], v21 offset:2560
  ds_read_b64_tr_b16 v[66:67], v21 offset:2720
  ds_read_b64_tr_b16 v[68:69], v21 offset:2600
  ds_read_b64_tr_b16 v[70:71], v21 offset:2760
  s_waitcnt lgkmcnt(13)
  v_mfma_f32_32x32x16_bf16 v[24:39], v[72:75], v[152:155], v[24:39]
  v_mfma_f32_32x32x16_bf16 v[40:55], v[76:79], v[152:155], v[40:55]
  ds_read_b32 v89, v22 offset:12
  ds_read_b64_tr_b16 v[72:73], v21 offset:5120
  ds_read_b64_tr_b16 v[74:75], v21 offset:5280
  ds_read_b64_tr_b16 v[76:77], v21 offset:5160
  ds_read_b64_tr_b16 v[78:79], v21 offset:5320
  s_waitcnt lgkmcnt(14)
  v_mfma_f32_32x32x16_bf16 v[24:39], v[80:83], v[156:159], v[24:39]
  v_mfma_f32_32x32x16_bf16 v[40:55], v[84:87], v[156:159], v[40:55]
  ds_read_b64_tr_b16 v[80:81], v21 offset:7680
  ds_read_b64_tr_b16 v[82:83], v21 offset:7840
  ds_read_b64_tr_b16 v[84:85], v21 offset:7720
  ds_read_b64_tr_b16 v[86:87], v21 offset:7880
  s_mov_b64 exec, 1
  ds_add_u32 v22, v23 offset:124
  s_mov_b64 exec, -1
  s_waitcnt lgkmcnt(14)
  v_mfma_f32_32x32x16_bf16 v[24:39], v[56:59], v[160:163], v[24:39]
  v_mfma_f32_32x32x16_bf16 v[40:55], v[60:63], v[160:163], v[40:55]
  s_waitcnt lgkmcnt(9)
F_qv1:
  v_readfirstlane_b32 s3, v89
  s_cmp_ge_u32 s3, 2
  s_cbranch_scc1 F_qv1_go

  ds_read_b32 v89, v22 offset:12
  s_add_u32 s5, s5, 1
  s_cmp_lt_u32 s5, 1600000
  s_waitcnt lgkmcnt(0)
  s_cbranch_scc1 F_qv1

F_qv1_go:
  ds_read_b64_tr_b16 v[56:57], v21 offset:10240
  ds_read_b64_tr_b16 v[58:59], v21 offset:10400
  ds_read_b64_tr_b16 v[60:61], v21 offset:10280
  ds_read_b64_tr_b16 v[62:63], v21 offset:10440
  v_mfma_f32_32x32x16_bf16 v[24:39], v[64:67], v[164:167], v[24:39]
  v_mfma_f32_32x32x16_bf16 v[40:55], v[68:71], v[164:167], v[40:55]
  ds_read_b64_tr_b16 v[64:65], v21 offset:12800
  ds_read_b64_tr_b16 v[66:67], v21 offset:12960
  ds_read_b64_tr_b16 v[68:69], v21 offset:12840
  ds_read_b64_tr_b16 v[70:71], v21 offset:13000
  s_waitcnt lgkmcnt(13)
  v_mfma_f32_32x32x16_bf16 v[24:39], v[72:75], v[168:171], v[24:39]
  v_mfma_f32_32x32x16_bf16 v[40:55], v[76:79], v[168:171], v[40:55]
  ds_read_b32 v88, v22 offset:8
  ds_read_b64_tr_b16 v[72:73], v21 offset:15360
  ds_read_b64_tr_b16 v[74:75], v21 offset:15520
  ds_read_b64_tr_b16 v[76:77], v21 offset:15400
  ds_read_b64_tr_b16 v[78:79], v21 offset:15560
  s_waitcnt lgkmcnt(14)
  v_mfma_f32_32x32x16_bf16 v[24:39], v[80:83], v[96:99], v[24:39]
  v_mfma_f32_32x32x16_bf16 v[40:55], v[84:87], v[96:99], v[40:55]
  ds_read_b64_tr_b16 v[80:81], v21 offset:17920
  ds_read_b64_tr_b16 v[82:83], v21 offset:18080
  ds_read_b64_tr_b16 v[84:85], v21 offset:17960
  ds_read_b64_tr_b16 v[86:87], v21 offset:18120
  s_mov_b64 exec, 1
  ds_add_u32 v22, v23 offset:20
  s_mov_b64 exec, -1
  s_waitcnt lgkmcnt(14)
  v_mfma_f32_32x32x16_bf16 v[24:39], v[56:59], v[100:103], v[24:39]
  v_mfma_f32_32x32x16_bf16 v[40:55], v[60:63], v[100:103], v[40:55]
  s_waitcnt lgkmcnt(9)
F_qw2:
  v_readfirstlane_b32 s3, v88
  s_cmp_ge_u32 s3, 3
  s_cbranch_scc1 F_qw2_go

  ds_read_b32 v88, v22 offset:8
  s_add_u32 s5, s5, 1
  s_cmp_lt_u32 s5, 1600000
  s_waitcnt lgkmcnt(0)
  s_cbranch_scc1 F_qw2

F_qw2_go:
  v_add_u32 v21, 122880, v20
  ds_read_b64_tr_b16 v[56:57], v21 offset:0
  ds_read_b64_tr_b16 v[58:59], v21 offset:160
  ds_read_b64_tr_b16 v[60:61], v21 offset:40
  ds_read_b64_tr_b16 v[62:63], v21 offset:200
  v_mfma_f32_32x32x16_bf16 v[24:39], v[64:67], v[104:107], v[24:39]
  v_mfma_f32_32x32x16_bf16 v[40:55], v[68:71], v[104:107], v[40:55]
  ds_read_b64_tr_b16 v[64:65], v21 offset:2560
  ds_read_b64_tr_b16 v[66:67], v21 offset:2720
  ds_read_b64_tr_b16 v[68:69], v21 offset:2600
  ds_read_b64_tr_b16 v[70:71], v21 offset:2760
  s_waitcnt lgkmcnt(13)
  v_mfma_f32_32x32x16_bf16 v[24:39], v[72:75], v[108:111], v[24:39]
  v_mfma_f32_32x32x16_bf16 v[40:55], v[76:79], v[108:111], v[40:55]
  ds_read_b32 v89, v22 offset:12
  ds_read_b64_tr_b16 v[72:73], v21 offset:5120
  ds_read_b64_tr_b16 v[74:75], v21 offset:5280
  ds_read_b64_tr_b16 v[76:77], v21 offset:5160
  ds_read_b64_tr_b16 v[78:79], v21 offset:5320
  s_waitcnt lgkmcnt(14)
  v_mfma_f32_32x32x16_bf16 v[24:39], v[80:83], v[112:115], v[24:39]
  v_mfma_f32_32x32x16_bf16 v[40:55], v[84:87], v[112:115], v[40:55]
  ds_read_b64_tr_b16 v[80:81], v21 offset:7680
  ds_read_b64_tr_b16 v[82:83], v21 offset:7840
  ds_read_b64_tr_b16 v[84:85], v21 offset:7720
  ds_read_b64_tr_b16 v[86:87], v21 offset:7880
  s_waitcnt lgkmcnt(13)
  v_mfma_f32_32x32x16_bf16 v[24:39], v[56:59], v[116:119], v[24:39]
  v_mfma_f32_32x32x16_bf16 v[40:55], v[60:63], v[116:119], v[40:55]
  s_waitcnt lgkmcnt(8)
F_qv2:
  v_readfirstlane_b32 s3, v89
  s_cmp_ge_u32 s3, 3
  s_cbranch_scc1 F_qv2_go

  ds_read_b32 v89, v22 offset:12
  s_add_u32 s5, s5, 1
  s_cmp_lt_u32 s5, 1600000
  s_waitcnt lgkmcnt(0)
  s_cbranch_scc1 F_qv2

F_qv2_go:
  ds_read_b64_tr_b16 v[56:57], v21 offset:10240
  ds_read_b64_tr_b16 v[58:59], v21 offset:10400
  ds_read_b64_tr_b16 v[60:61], v21 offset:10280
  ds_read_b64_tr_b16 v[62:63], v21 offset:10440
  v_mfma_f32_32x32x16_bf16 v[24:39], v[64:67], v[120:123], v[24:39]
  v_mfma_f32_32x32x16_bf16 v[40:55], v[68:71], v[120:123], v[40:55]
  ds_read_b64_tr_b16 v[64:65], v21 offset:12800
  ds_read_b64_tr_b16 v[66:67], v21 offset:12960
  ds_read_b64_tr_b16 v[68:69], v21 offset:12840
  ds_read_b64_tr_b16 v[70:71], v21 offset:13000
  s_waitcnt lgkmcnt(12)
  v_mfma_f32_32x32x16_bf16 v[24:39], v[72:75], v[124:127], v[24:39]
  v_mfma_f32_32x32x16_bf16 v[40:55], v[76:79], v[124:127], v[40:55]
  ds_read_b32 v88, v22 offset:8
  ds_read_b64_tr_b16 v[72:73], v21 offset:15360
  ds_read_b64_tr_b16 v[74:75], v21 offset:15520
  ds_read_b64_tr_b16 v[76:77], v21 offset:15400
  ds_read_b64_tr_b16 v[78:79], v21 offset:15560
  s_waitcnt lgkmcnt(13)
  v_mfma_f32_32x32x16_bf16 v[24:39], v[80:83], v[128:131], v[24:39]
  v_mfma_f32_32x32x16_bf16 v[40:55], v[84:87], v[128:131], v[40:55]
  ds_read_b64_tr_b16 v[80:81], v21 offset:17920
  ds_read_b64_tr_b16 v[82:83], v21 offset:18080
  ds_read_b64_tr_b16 v[84:85], v21 offset:17960
  ds_read_b64_tr_b16 v[86:87], v21 offset:18120
  s_mov_b64 exec, 1
  ds_add_u32 v22, v23 offset:24
  s_mov_b64 exec, -1
  s_waitcnt lgkmcnt(14)
  v_mfma_f32_32x32x16_bf16 v[24:39], v[56:59], v[132:135], v[24:39]
  v_mfma_f32_32x32x16_bf16 v[40:55], v[60:63], v[132:135], v[40:55]
  s_waitcnt lgkmcnt(9)
F_qw3:
  v_readfirstlane_b32 s3, v88
  s_cmp_ge_u32 s3, 4
  s_cbranch_scc1 F_qw3_go

  ds_read_b32 v88, v22 offset:8
  s_add_u32 s5, s5, 1
  s_cmp_lt_u32 s5, 1600000
  s_waitcnt lgkmcnt(0)
  s_cbranch_scc1 F_qw3

F_qw3_go:
  v_add_u32 v21, 81920, v20
  ds_read_b64_tr_b16 v[56:57], v21 offset:0
  ds_read_b64_tr_b16 v[58:59], v21 offset:160
  ds_read_b64_tr_b16 v[60:61], v21 offset:40
  ds_read_b64_tr_b16 v[62:63], v21 offset:200
  v_mfma_f32_32x32x16_bf16 v[24:39], v[64:67], v[136:139], v[24:39]
  v_mfma_f32_32x32x16_bf16 v[40:55], v[68:71], v[136:139], v[40:55]
  ds_read_b64_tr_b16 v[64:65], v21 offset:2560
  ds_read_b64_tr_b16 v[66:67], v21 offset:2720
  ds_read_b64_tr_b16 v[68:69], v21 offset:2600
  ds_read_b64_tr_b16 v[70:71], v21 offset:2760
  s_waitcnt lgkmcnt(13)
  v_mfma_f32_32x32x16_bf16 v[24:39], v[72:75], v[140:143], v[24:39]
  v_mfma_f32_32x32x16_bf16 v[40:55], v[76:79], v[140:143], v[40:55]
  ds_read_b32 v89, v22 offset:12
  ds_read_b64_tr_b16 v[72:73], v21 offset:5120
  ds_read_b64_tr_b16 v[74:75], v21 offset:5280
  ds_read_b64_tr_b16 v[76:77], v21 offset:5160
  ds_read_b64_tr_b16 v[78:79], v21 offset:5320
  s_waitcnt lgkmcnt(14)
  v_mfma_f32_32x32x16_bf16 v[24:39], v[80:83], v[172:175], v[24:39]
  v_mfma_f32_32x32x16_bf16 v[40:55], v[84:87], v[172:175], v[40:55]
  ds_read_b64_tr_b16 v[80:81], v21 offset:7680
  ds_read_b64_tr_b16 v[82:83], v21 offset:7840
  ds_read_b64_tr_b16 v[84:85], v21 offset:7720
  ds_read_b64_tr_b16 v[86:87], v21 offset:7880
  s_waitcnt lgkmcnt(13)
  v_mfma_f32_32x32x16_bf16 v[24:39], v[56:59], v[176:179], v[24:39]
  v_mfma_f32_32x32x16_bf16 v[40:55], v[60:63], v[176:179], v[40:55]
  s_waitcnt lgkmcnt(8)
F_qv3:
  v_readfirstlane_b32 s3, v89
  s_cmp_ge_u32 s3, 4
  s_cbranch_scc1 F_qv3_go

  ds_read_b32 v89, v22 offset:12
  s_add_u32 s5, s5, 1
  s_cmp_lt_u32 s5, 1600000
  s_waitcnt lgkmcnt(0)
  s_cbranch_scc1 F_qv3

F_qv3_go:
  ds_read_b64_tr_b16 v[56:57], v21 offset:10240
  ds_read_b64_tr_b16 v[58:59], v21 offset:10400
  ds_read_b64_tr_b16 v[60:61], v21 offset:10280
  ds_read_b64_tr_b16 v[62:63], v21 offset:10440
  v_mfma_f32_32x32x16_bf16 v[24:39], v[64:67], v[180:183], v[24:39]
  v_mov_b64 v[246:247], 0
  v_mfma_f32_32x32x16_bf16 v[40:55], v[68:71], v[180:183], v[40:55]
  v_mov_b64 v[248:249], 0
  ds_read_b64_tr_b16 v[64:65], v21 offset:12800
  ds_read_b64_tr_b16 v[66:67], v21 offset:12960
  ds_read_b64_tr_b16 v[68:69], v21 offset:12840
  ds_read_b64_tr_b16 v[70:71], v21 offset:13000
  s_waitcnt lgkmcnt(12)
  v_mfma_f32_32x32x16_bf16 v[24:39], v[72:75], v[184:187], v[24:39]
  v_mov_b64 v[250:251], 0
  v_mfma_f32_32x32x16_bf16 v[40:55], v[76:79], v[184:187], v[40:55]
  v_mov_b64 v[252:253], 0
  ds_read_b32 v88, v22 offset:8
  ds_read_b64_tr_b16 v[72:73], v21 offset:15360
  ds_read_b64_tr_b16 v[74:75], v21 offset:15520
  ds_read_b64_tr_b16 v[76:77], v21 offset:15400
  ds_read_b64_tr_b16 v[78:79], v21 offset:15560
  s_waitcnt lgkmcnt(13)
  v_mfma_f32_32x32x16_bf16 v[24:39], v[80:83], v[188:191], v[24:39]
  v_mov_b64 v[96:97], 0
  v_mfma_f32_32x32x16_bf16 v[40:55], v[84:87], v[188:191], v[40:55]
  v_mov_b64 v[98:99], 0
  ds_read_b64_tr_b16 v[80:81], v21 offset:17920
  ds_read_b64_tr_b16 v[82:83], v21 offset:18080
  ds_read_b64_tr_b16 v[84:85], v21 offset:17960
  ds_read_b64_tr_b16 v[86:87], v21 offset:18120
  s_mov_b64 exec, 1
  ds_add_u32 v22, v23 offset:28
  s_mov_b64 exec, -1
  s_waitcnt lgkmcnt(14)
  v_mfma_f32_32x32x16_bf16 v[24:39], v[56:59], v[192:195], v[24:39]
  v_mov_b64 v[100:101], 0
  v_mfma_f32_32x32x16_bf16 v[40:55], v[60:63], v[192:195], v[40:55]
  v_mov_b64 v[102:103], 0
  s_waitcnt lgkmcnt(9)
F_qw4:
  v_readfirstlane_b32 s3, v88
  s_cmp_ge_u32 s3, 5
  s_cbranch_scc1 F_qw4_go

  ds_read_b32 v88, v22 offset:8
  s_add_u32 s5, s5, 1
  s_cmp_lt_u32 s5, 1600000
  s_waitcnt lgkmcnt(0)
  s_cbranch_scc1 F_qw4

F_qw4_go:
  v_add_u32 v21, 102400, v20
  ds_read_b64_tr_b16 v[56:57], v21 offset:0
  ds_read_b64_tr_b16 v[58:59], v21 offset:160
  ds_read_b64_tr_b16 v[60:61], v21 offset:40
  ds_read_b64_tr_b16 v[62:63], v21 offset:200
  v_mfma_f32_32x32x16_bf16 v[24:39], v[64:67], v[196:199], v[24:39]
  v_mov_b64 v[104:105], 0
  v_mfma_f32_32x32x16_bf16 v[40:55], v[68:71], v[196:199], v[40:55]
  v_mov_b64 v[106:107], 0
  ds_read_b64_tr_b16 v[64:65], v21 offset:2560
  ds_read_b64_tr_b16 v[66:67], v21 offset:2720
  ds_read_b64_tr_b16 v[68:69], v21 offset:2600
  ds_read_b64_tr_b16 v[70:71], v21 offset:2760
  s_waitcnt lgkmcnt(13)
  v_mfma_f32_32x32x16_bf16 v[24:39], v[72:75], v[200:203], v[24:39]
  v_mov_b64 v[108:109], 0
  v_mfma_f32_32x32x16_bf16 v[40:55], v[76:79], v[200:203], v[40:55]
  v_mov_b64 v[110:111], 0
  ds_read_b32 v89, v22 offset:12
  ds_read_b64_tr_b16 v[72:73], v21 offset:5120
  ds_read_b64_tr_b16 v[74:75], v21 offset:5280
  ds_read_b64_tr_b16 v[76:77], v21 offset:5160
  ds_read_b64_tr_b16 v[78:79], v21 offset:5320
  s_waitcnt lgkmcnt(14)
  v_mfma_f32_32x32x16_bf16 v[24:39], v[80:83], v[204:207], v[24:39]
  v_mov_b64 v[112:113], 0
  v_mfma_f32_32x32x16_bf16 v[40:55], v[84:87], v[204:207], v[40:55]
  v_mov_b64 v[114:115], 0
  ds_read_b64_tr_b16 v[80:81], v21 offset:7680
  ds_read_b64_tr_b16 v[82:83], v21 offset:7840
  ds_read_b64_tr_b16 v[84:85], v21 offset:7720
  ds_read_b64_tr_b16 v[86:87], v21 offset:7880
  s_waitcnt lgkmcnt(13)
  v_mfma_f32_32x32x16_bf16 v[24:39], v[56:59], v[208:211], v[24:39]
  v_mov_b64 v[116:117], 0
  v_mfma_f32_32x32x16_bf16 v[40:55], v[60:63], v[208:211], v[40:55]
  v_mov_b64 v[118:119], 0
  s_waitcnt lgkmcnt(8)
F_qv4:
  v_readfirstlane_b32 s3, v89
  s_cmp_ge_u32 s3, 5
  s_cbranch_scc1 F_qv4_go

  ds_read_b32 v89, v22 offset:12
  s_add_u32 s5, s5, 1
  s_cmp_lt_u32 s5, 1600000
  s_waitcnt lgkmcnt(0)
  s_cbranch_scc1 F_qv4

F_qv4_go:
  ds_read_b64_tr_b16 v[56:57], v21 offset:10240
  ds_read_b64_tr_b16 v[58:59], v21 offset:10400
  ds_read_b64_tr_b16 v[60:61], v21 offset:10280
  ds_read_b64_tr_b16 v[62:63], v21 offset:10440
  v_mfma_f32_32x32x16_bf16 v[24:39], v[64:67], v[212:215], v[24:39]
  v_mov_b64 v[120:121], 0
  v_mfma_f32_32x32x16_bf16 v[40:55], v[68:71], v[212:215], v[40:55]
  v_mov_b64 v[122:123], 0
  ds_read_b64_tr_b16 v[64:65], v21 offset:12800
  ds_read_b64_tr_b16 v[66:67], v21 offset:12960
  ds_read_b64_tr_b16 v[68:69], v21 offset:12840
  ds_read_b64_tr_b16 v[70:71], v21 offset:13000
  s_waitcnt lgkmcnt(12)
  v_mfma_f32_32x32x16_bf16 v[24:39], v[72:75], v[216:219], v[24:39]
  v_mov_b64 v[124:125], 0
  v_mfma_f32_32x32x16_bf16 v[40:55], v[76:79], v[216:219], v[40:55]
  v_mov_b64 v[126:127], 0
  ds_read_b64_tr_b16 v[72:73], v21 offset:15360
  ds_read_b64_tr_b16 v[74:75], v21 offset:15520
  ds_read_b64_tr_b16 v[76:77], v21 offset:15400
  ds_read_b64_tr_b16 v[78:79], v21 offset:15560
  s_waitcnt lgkmcnt(12)
  v_mfma_f32_32x32x16_bf16 v[24:39], v[80:83], v[220:223], v[24:39]
  v_mov_b64 v[128:129], 0
  v_mfma_f32_32x32x16_bf16 v[40:55], v[84:87], v[220:223], v[40:55]
  v_mov_b64 v[130:131], 0
  ds_read_b64_tr_b16 v[80:81], v21 offset:17920
  ds_read_b64_tr_b16 v[82:83], v21 offset:18080
  ds_read_b64_tr_b16 v[84:85], v21 offset:17960
  ds_read_b64_tr_b16 v[86:87], v21 offset:18120
  s_mov_b64 exec, 1
  ds_add_u32 v22, v23 offset:32
  s_mov_b64 exec, -1
  s_waitcnt lgkmcnt(13)
  v_mfma_f32_32x32x16_bf16 v[24:39], v[56:59], v[224:227], v[24:39]
  v_mov_b64 v[132:133], 0
  v_mfma_f32_32x32x16_bf16 v[40:55], v[60:63], v[224:227], v[40:55]
  v_mov_b64 v[134:135], 0
  s_waitcnt lgkmcnt(9)
  v_mfma_f32_32x32x16_bf16 v[24:39], v[64:67], v[228:231], v[24:39]
  v_mov_b64 v[136:137], 0
  v_mfma_f32_32x32x16_bf16 v[40:55], v[68:71], v[228:231], v[40:55]
  v_mov_b64 v[138:139], 0
  ds_read_b32 v7, v22 offset:116
  ds_read_b32 v8, v22 offset:28
  s_waitcnt lgkmcnt(7)
  v_mfma_f32_32x32x16_bf16 v[24:39], v[72:75], v[232:235], v[24:39]
  v_mov_b64 v[140:141], 0
  v_mfma_f32_32x32x16_bf16 v[40:55], v[76:79], v[232:235], v[40:55]
  v_mov_b64 v[142:143], 0
  s_waitcnt lgkmcnt(1)
  v_mfma_f32_32x32x16_bf16 v[24:39], v[80:83], v[236:239], v[24:39]
  v_mfma_f32_32x32x16_bf16 v[40:55], v[84:87], v[236:239], v[40:55]
  v_cmp_ne_u32 vcc, 0, v7
  s_cbranch_vccz F_kv1
  buffer_load_dwordx4 v[242:245], v12, s[48:51], s15 offen sc1
  buffer_load_dwordx2 v[254:255], v13, s[48:51], s15 offen offset:1024 sc1
  buffer_load_dwordx4 v[144:147], v12, s[48:51], s14 offen sc1
  buffer_load_dwordx2 v[156:157], v13, s[48:51], s14 offen offset:1024 sc1
  buffer_load_dwordx4 v[148:151], v14, s[48:51], s14 offen offset:1408 sc1
  buffer_load_dwordx4 v[152:155], v14, s[48:51], s14 offen offset:2080 sc1
  s_add_u32 s14, s14, 2816
  s_cmp_eq_u32 s14, s13
  s_cselect_b32 s14, s12, s14
F_kv1:
  v_mov_b64 v[88:89], 0
  v_mov_b64 v[90:91], 0
  v_mov_b64 v[92:93], 0
  v_mov_b64 v[94:95], 0
  v_mov_b64 v[80:81], 0
  v_mov_b64 v[82:83], 0
  v_mov_b64 v[84:85], 0
  v_mov_b64 v[86:87], 0
  v_mov_b32 v228, v5
  v_xor_b32 v229, 8, v6
  s_waitcnt lgkmcnt(0)
  v_readfirstlane_b32 s18, v8
  v_mov_b32 v8, 0x3ea52b5c
  s_nop 4

  v_pk_mul_f32 v[24:25], v[24:25], v[8:9] op_sel_hi:[1,0]
  v_pk_mul_f32 v[26:27], v[26:27], v[8:9] op_sel_hi:[1,0]
  v_pk_mul_f32 v[28:29], v[28:29], v[8:9] op_sel_hi:[1,0]
  v_pk_mul_f32 v[30:31], v[30:31], v[8:9] op_sel_hi:[1,0]
  v_pk_mul_f32 v[32:33], v[32:33], v[8:9] op_sel_hi:[1,0]
  v_pk_mul_f32 v[34:35], v[34:35], v[8:9] op_sel_hi:[1,0]
  v_cvt_pk_bf16_f32 v16, v24, v25
  v_cvt_pk_bf16_f32 v17, v26, v27
  v_cvt_pk_bf16_f32 v18, v28, v29
  v_cvt_pk_bf16_f32 v19, v30, v31
  v_cvt_pk_bf16_f32 v32, v32, v33
  v_cvt_pk_bf16_f32 v33, v34, v35
  v_pk_mul_f32 v[40:41], v[40:41], v[8:9] op_sel_hi:[1,0]
  v_pk_mul_f32 v[42:43], v[42:43], v[8:9] op_sel_hi:[1,0]
  v_pk_mul_f32 v[44:45], v[44:45], v[8:9] op_sel_hi:[1,0]
  v_pk_mul_f32 v[46:47], v[46:47], v[8:9] op_sel_hi:[1,0]
  v_pk_mul_f32 v[48:49], v[48:49], v[8:9] op_sel_hi:[1,0]
  v_pk_mul_f32 v[50:51], v[50:51], v[8:9] op_sel_hi:[1,0]
  v_cvt_pk_bf16_f32 v20, v40, v41
  v_cvt_pk_bf16_f32 v21, v42, v43
  v_cvt_pk_bf16_f32 v22, v44, v45
  v_cvt_pk_bf16_f32 v23, v46, v47
  v_cvt_pk_bf16_f32 v34, v48, v49
  v_cvt_pk_bf16_f32 v35, v50, v51
  s_mov_b32 exec_lo, 0
  v_mov_b64 v[32:33], 0
  v_mov_b64 v[34:35], 0
  s_mov_b32 exec_lo, -1
  s_cmp_ge_u32 s18, 4
  s_cbranch_scc1 F_q3ok

  v_mov_b32 v9, 161792
  s_mov_b32 s4, 0
F_l3:
  ds_read_b32 v8, v9 offset:28
  s_add_u32 s4, s4, 1
  s_waitcnt lgkmcnt(0)
  v_readfirstlane_b32 s3, v8
  s_cmp_ge_u32 s3, 4
  s_cbranch_scc1 F_l3_ok

  s_cmp_lt_u32 s4, 1600000
  s_cbranch_scc1 F_l3

F_l3_ok:
F_q3ok:
  ds_write_b128 v4, v[16:19] offset:0
  ds_write_b128 v4, v[20:23] offset:1024
  s_cbranch_vccnz F_kvok
  v_mov_b32 v9, 161792
  s_mov_b32 s4, 0
F_l4:
  ds_read_b32 v8, v9 offset:116
  s_add_u32 s4, s4, 1
  s_waitcnt lgkmcnt(0)
  v_readfirstlane_b32 s3, v8
  s_cmp_ge_u32 s3, 1
  s_cbranch_scc1 F_l4_ok

  s_cmp_lt_u32 s4, 1600000
  s_cbranch_scc1 F_l4

F_l4_ok:
  buffer_load_dwordx4 v[242:245], v12, s[48:51], s15 offen sc1
  buffer_load_dwordx2 v[254:255], v13, s[48:51], s15 offen offset:1024 sc1
  buffer_load_dwordx4 v[144:147], v12, s[48:51], s14 offen sc1
  buffer_load_dwordx2 v[156:157], v13, s[48:51], s14 offen offset:1024 sc1
  buffer_load_dwordx4 v[148:151], v14, s[48:51], s14 offen offset:1408 sc1
  buffer_load_dwordx4 v[152:155], v14, s[48:51], s14 offen offset:2080 sc1
  s_add_u32 s14, s14, 2816
  s_cmp_eq_u32 s14, s13
  s_cselect_b32 s14, s12, s14
F_kvok:
  v_mov_b64 v[40:41], 0
  v_mov_b64 v[42:43], 0
  v_mov_b64 v[44:45], 0
  v_mov_b64 v[46:47], 0
  s_waitcnt vmcnt(4)
  v_mfma_f32_32x32x16_bf16 v[48:63], v[242:245], v[16:19], 0
  v_mfma_f32_32x32x8_bf16 v[48:63], v[254:255], v[32:33], v[48:63]
  v_mfma_f32_32x32x16_bf16 v[64:79], v[242:245], v[20:23], 0
  v_mfma_f32_32x32x8_bf16 v[64:79], v[254:255], v[34:35], v[64:79]
  buffer_load_dwordx4 v[158:161], v12, s[48:51], s14 offen sc1
  buffer_load_dwordx2 v[170:171], v13, s[48:51], s14 offen offset:1024 sc1
  buffer_load_dwordx4 v[162:165], v14, s[48:51], s14 offen offset:1408 sc1
  buffer_load_dwordx4 v[166:169], v14, s[48:51], s14 offen offset:2080 sc1
  s_add_u32 s14, s14, 2816
  s_cmp_eq_u32 s14, s13
  s_cselect_b32 s14, s12, s14
  buffer_load_dwordx4 v[172:175], v12, s[48:51], s14 offen sc1
  buffer_load_dwordx2 v[184:185], v13, s[48:51], s14 offen offset:1024 sc1
  buffer_load_dwordx4 v[176:179], v14, s[48:51], s14 offen offset:1408 sc1
  buffer_load_dwordx4 v[180:183], v14, s[48:51], s14 offen offset:2080 sc1
  s_add_u32 s14, s14, 2816
  s_cmp_eq_u32 s14, s13
  s_cselect_b32 s14, s12, s14
  s_nop 2
  v_max3_f32 v9, v48, v49, v50
  v_max3_f32 v9, v9, v51, v52
  v_max3_f32 v9, v9, v53, v54
  v_max3_f32 v9, v9, v55, v56
  v_max3_f32 v9, v9, v57, v58
  v_max3_f32 v9, v9, v59, v60
  v_max3_f32 v9, v9, v61, v62
  v_max_f32 v9, v9, v63
  s_mov_b32 exec_lo, 0
  v_cvt_pk_bf16_f32 v32, -v9, 0
  s_mov_b32 exec_lo, -1
  s_waitcnt vmcnt(8)
  v_mfma_f32_32x32x16_bf16 v[48:63], v[144:147], v[16:19], 0
  v_mfma_f32_32x32x8_bf16 v[48:63], v[156:157], v[32:33], v[48:63]
  v_max3_f32 v9, v64, v65, v66
  v_max3_f32 v9, v9, v67, v68
  v_max3_f32 v9, v9, v69, v70
  v_max3_f32 v9, v9, v71, v72
  v_max3_f32 v9, v9, v73, v74
  v_max3_f32 v9, v9, v75, v76
  v_max3_f32 v9, v9, v77, v78
  v_max_f32 v9, v9, v79
  s_mov_b32 exec_lo, 0
  v_cvt_pk_bf16_f32 v34, -v9, 0
  s_mov_b32 exec_lo, -1
  ds_write_b128 v4, v[32:35] offset:2048
  ds_write_b32 v6, v6

  s_nop 3
  s_setprio 2
  s_mov_b32 s19, 0
  v_mfma_f32_32x32x16_bf16 v[64:79], v[144:147], v[20:23], 0
  buffer_load_dwordx4 v[186:189], v12, s[44:47], s14 offen sc1
  v_exp_f32 v48, v48
  v_exp_f32 v49, v49
  v_exp_f32 v50, v50
  v_exp_f32 v51, v51
  v_mfma_f32_32x32x16_bf16 v[128:143], v[246:249], v[40:43], v[128:143]
  buffer_load_dwordx2 v[198:199], v13, s[44:47], s14 offen offset:1024 sc1
  v_exp_f32 v52, v52
  v_exp_f32 v53, v53
  v_exp_f32 v54, v54
  v_exp_f32 v55, v55
  v_mfma_f32_32x32x8_bf16 v[64:79], v[156:157], v[34:35], v[64:79]
  v_cvt_pk_bf16_f32 v4, v48, v49
  v_cvt_pk_bf16_f32 v5, v50, v51
  v_cvt_pk_bf16_f32 v6, v52, v53
  v_cvt_pk_bf16_f32 v7, v54, v55
  v_exp_f32 v56, v56
  v_exp_f32 v57, v57
  v_exp_f32 v58, v58
  v_exp_f32 v59, v59
  v_mfma_f32_32x32x16_bf16 v[128:143], v[250:253], v[44:47], v[128:143]
  ds_read_b32 v230, v229
  ds_read_b128 v[24:27], v228
  ds_read_b128 v[28:31], v228 offset:1024
  ds_read_b128 v[36:39], v228 offset:2048
  buffer_load_dwordx4 v[190:193], v14, s[44:47], s14 offen offset:1408 sc1
  v_exp_f32 v60, v60
  v_exp_f32 v61, v61
  v_exp_f32 v62, v62
  v_exp_f32 v63, v63
  v_cvt_pk_bf16_f32 v8, v56, v57
  v_cvt_pk_bf16_f32 v9, v58, v59
  v_cvt_pk_bf16_f32 v10, v60, v61
  v_cvt_pk_bf16_f32 v11, v62, v63
  s_mov_b32 s4, 0
F_qx1:
  s_waitcnt lgkmcnt(0)
  v_readfirstlane_b32 s3, v230
  s_add_u32 s4, s4, 1
  s_cmp_lg_u32 s3, 0
  s_cbranch_scc1 F_qx2
  ds_read_b32 v230, v229
  ds_read_b128 v[24:27], v228
  ds_read_b128 v[28:31], v228 offset:1024
  ds_read_b128 v[36:39], v228 offset:2048
  s_cmp_lt_u32 s4, 1600000
  s_cbranch_scc1 F_qx1

F_qx2:
  v_mov_b32 v228, 161792
  v_mov_b32 v229, 1
  s_mov_b64 exec, 1
  ds_add_u32 v228, v229 offset:36
  s_mov_b64 exec, -1

  v_mfma_f32_32x32x16_bf16 v[48:63], v[144:147], v[24:27], 0
  buffer_load_dwordx4 v[194:197], v14, s[44:47], s14 offen offset:2080 sc1
  s_add_u32 s14, s14, 2816
  v_exp_f32 v64, v64
  v_exp_f32 v65, v65
  v_exp_f32 v66, v66
  v_exp_f32 v67, v67
  v_mfma_f32_32x32x16_bf16 v[80:95], v[148:151], v[4:7], v[80:95]
  s_cmp_eq_u32 s14, s13
  s_cselect_b32 s14, s12, s14
  v_exp_f32 v68, v68
  v_exp_f32 v69, v69
  v_exp_f32 v70, v70
  v_exp_f32 v71, v71
  v_mfma_f32_32x32x8_bf16 v[48:63], v[156:157], v[36:37], v[48:63]
  v_cvt_pk_bf16_f32 v40, v64, v65
  v_cvt_pk_bf16_f32 v41, v66, v67
  v_cvt_pk_bf16_f32 v42, v68, v69
  v_cvt_pk_bf16_f32 v43, v70, v71
  v_exp_f32 v72, v72
  v_exp_f32 v73, v73
  v_exp_f32 v74, v74
  v_exp_f32 v75, v75
  v_mfma_f32_32x32x16_bf16 v[80:95], v[152:155], v[8:11], v[80:95]
  buffer_load_dwordx4 v[200:203], v12, s[44:47], s14 offen sc1
  v_exp_f32 v76, v76
  v_exp_f32 v77, v77
  v_exp_f32 v78, v78
  v_exp_f32 v79, v79
  v_cvt_pk_bf16_f32 v44, v72, v73
  v_cvt_pk_bf16_f32 v45, v74, v75
  v_cvt_pk_bf16_f32 v46, v76, v77
  v_cvt_pk_bf16_f32 v47, v78, v79
  v_mfma_f32_32x32x16_bf16 v[64:79], v[144:147], v[28:31], 0
  buffer_load_dwordx2 v[212:213], v13, s[44:47], s14 offen offset:1024 sc1
  v_exp_f32 v48, v48
  v_exp_f32 v49, v49
  v_exp_f32 v50, v50
  v_exp_f32 v51, v51
  v_mfma_f32_32x32x16_bf16 v[96:111], v[148:151], v[40:43], v[96:111]
  buffer_load_dwordx4 v[204:207], v14, s[44:47], s14 offen offset:1408 sc1
  v_exp_f32 v52, v52
  v_exp_f32 v53, v53
  v_exp_f32 v54, v54
  v_exp_f32 v55, v55
  v_mfma_f32_32x32x8_bf16 v[64:79], v[156:157], v[38:39], v[64:79]
  v_cvt_pk_bf16_f32 v4, v48, v49
  v_cvt_pk_bf16_f32 v5, v50, v51
  v_cvt_pk_bf16_f32 v6, v52, v53
  v_cvt_pk_bf16_f32 v7, v54, v55
  v_exp_f32 v56, v56
  v_exp_f32 v57, v57
  v_exp_f32 v58, v58
  v_exp_f32 v59, v59
  v_mfma_f32_32x32x16_bf16 v[96:111], v[152:155], v[44:47], v[96:111]
  s_waitcnt vmcnt(11)
  v_exp_f32 v60, v60
  v_exp_f32 v61, v61
  v_exp_f32 v62, v62
  v_exp_f32 v63, v63
  v_cvt_pk_bf16_f32 v8, v56, v57
  v_cvt_pk_bf16_f32 v9, v58, v59
  v_cvt_pk_bf16_f32 v10, v60, v61
  v_cvt_pk_bf16_f32 v11, v62, v63
  v_mfma_f32_32x32x16_bf16 v[48:63], v[158:161], v[16:19], 0
  buffer_load_dwordx4 v[208:211], v14, s[44:47], s14 offen offset:2080 sc1
  s_add_u32 s14, s14, 2816
  v_exp_f32 v64, v64
  v_exp_f32 v65, v65
  v_exp_f32 v66, v66
  v_exp_f32 v67, v67
  v_mfma_f32_32x32x16_bf16 v[112:127], v[148:151], v[4:7], v[112:127]
  s_cmp_eq_u32 s14, s13
  s_cselect_b32 s14, s12, s14
  v_exp_f32 v68, v68
  v_exp_f32 v69, v69
  v_exp_f32 v70, v70
  v_exp_f32 v71, v71
  v_mfma_f32_32x32x8_bf16 v[48:63], v[170:171], v[32:33], v[48:63]
  v_cvt_pk_bf16_f32 v40, v64, v65
  v_cvt_pk_bf16_f32 v41, v66, v67
  v_cvt_pk_bf16_f32 v42, v68, v69
  v_cvt_pk_bf16_f32 v43, v70, v71
  v_exp_f32 v72, v72
  v_exp_f32 v73, v73
  v_exp_f32 v74, v74
  v_exp_f32 v75, v75
  v_mfma_f32_32x32x16_bf16 v[112:127], v[152:155], v[8:11], v[112:127]
  v_exp_f32 v76, v76
  v_exp_f32 v77, v77
  v_exp_f32 v78, v78
  v_exp_f32 v79, v79
  v_cvt_pk_bf16_f32 v44, v72, v73
  v_cvt_pk_bf16_f32 v45, v74, v75
  v_cvt_pk_bf16_f32 v46, v76, v77
  v_cvt_pk_bf16_f32 v47, v78, v79
  v_mfma_f32_32x32x16_bf16 v[64:79], v[158:161], v[20:23], 0
  buffer_load_dwordx4 v[214:217], v12, s[44:47], s14 offen sc1
  v_exp_f32 v48, v48
  v_exp_f32 v49, v49
  v_exp_f32 v50, v50
  v_exp_f32 v51, v51
  v_mfma_f32_32x32x16_bf16 v[128:143], v[148:151], v[40:43], v[128:143]
  buffer_load_dwordx2 v[226:227], v13, s[44:47], s14 offen offset:1024 sc1
  v_exp_f32 v52, v52
  v_exp_f32 v53, v53
  v_exp_f32 v54, v54
  v_exp_f32 v55, v55
  v_mfma_f32_32x32x8_bf16 v[64:79], v[170:171], v[34:35], v[64:79]
  v_cvt_pk_bf16_f32 v4, v48, v49
  v_cvt_pk_bf16_f32 v5, v50, v51
  v_cvt_pk_bf16_f32 v6, v52, v53
  v_cvt_pk_bf16_f32 v7, v54, v55
  v_exp_f32 v56, v56
  v_exp_f32 v57, v57
  v_exp_f32 v58, v58
  v_exp_f32 v59, v59
  v_mfma_f32_32x32x16_bf16 v[128:143], v[152:155], v[44:47], v[128:143]
  buffer_load_dwordx4 v[218:221], v14, s[44:47], s14 offen offset:1408 sc1
  v_exp_f32 v60, v60
  v_exp_f32 v61, v61
  v_exp_f32 v62, v62
  v_exp_f32 v63, v63
  v_cvt_pk_bf16_f32 v8, v56, v57
  v_cvt_pk_bf16_f32 v9, v58, v59
  v_cvt_pk_bf16_f32 v10, v60, v61
  v_cvt_pk_bf16_f32 v11, v62, v63
  v_mfma_f32_32x32x16_bf16 v[48:63], v[158:161], v[24:27], 0
  buffer_load_dwordx4 v[222:225], v14, s[44:47], s14 offen offset:2080 sc1
  s_add_u32 s14, s14, 2816
  v_exp_f32 v64, v64
  v_exp_f32 v65, v65
  v_exp_f32 v66, v66
  v_exp_f32 v67, v67
  v_mfma_f32_32x32x16_bf16 v[80:95], v[162:165], v[4:7], v[80:95]
  s_cmp_eq_u32 s14, s13
  s_cselect_b32 s14, s12, s14
  v_exp_f32 v68, v68
  v_exp_f32 v69, v69
  v_exp_f32 v70, v70
  v_exp_f32 v71, v71
  v_mfma_f32_32x32x8_bf16 v[48:63], v[170:171], v[36:37], v[48:63]
  v_cvt_pk_bf16_f32 v40, v64, v65
  v_cvt_pk_bf16_f32 v41, v66, v67
  v_cvt_pk_bf16_f32 v42, v68, v69
  v_cvt_pk_bf16_f32 v43, v70, v71
  v_exp_f32 v72, v72
  v_exp_f32 v73, v73
  v_exp_f32 v74, v74
  v_exp_f32 v75, v75
  v_mfma_f32_32x32x16_bf16 v[80:95], v[166:169], v[8:11], v[80:95]
  buffer_load_dwordx4 v[228:231], v12, s[44:47], s14 offen sc1
  v_exp_f32 v76, v76
  v_exp_f32 v77, v77
  v_exp_f32 v78, v78
  v_exp_f32 v79, v79
  v_cvt_pk_bf16_f32 v44, v72, v73
  v_cvt_pk_bf16_f32 v45, v74, v75
  v_cvt_pk_bf16_f32 v46, v76, v77
  v_cvt_pk_bf16_f32 v47, v78, v79
  v_mfma_f32_32x32x16_bf16 v[64:79], v[158:161], v[28:31], 0
  buffer_load_dwordx2 v[240:241], v13, s[44:47], s14 offen offset:1024 sc1
  v_exp_f32 v48, v48
  v_exp_f32 v49, v49
  v_exp_f32 v50, v50
  v_exp_f32 v51, v51
  v_mfma_f32_32x32x16_bf16 v[96:111], v[162:165], v[40:43], v[96:111]
  buffer_load_dwordx4 v[232:235], v14, s[44:47], s14 offen offset:1408 sc1
  v_exp_f32 v52, v52
  v_exp_f32 v53, v53
  v_exp_f32 v54, v54
  v_exp_f32 v55, v55
  v_mfma_f32_32x32x8_bf16 v[64:79], v[170:171], v[38:39], v[64:79]
  v_cvt_pk_bf16_f32 v4, v48, v49
  v_cvt_pk_bf16_f32 v5, v50, v51
  v_cvt_pk_bf16_f32 v6, v52, v53
  v_cvt_pk_bf16_f32 v7, v54, v55
  v_exp_f32 v56, v56
  v_exp_f32 v57, v57
  v_exp_f32 v58, v58
  v_exp_f32 v59, v59
  v_mfma_f32_32x32x16_bf16 v[96:111], v[166:169], v[44:47], v[96:111]
  s_waitcnt vmcnt(15)
  v_exp_f32 v60, v60
  v_exp_f32 v61, v61
  v_exp_f32 v62, v62
  v_exp_f32 v63, v63
  v_cvt_pk_bf16_f32 v8, v56, v57
  v_cvt_pk_bf16_f32 v9, v58, v59
  v_cvt_pk_bf16_f32 v10, v60, v61
  v_cvt_pk_bf16_f32 v11, v62, v63
  v_mfma_f32_32x32x16_bf16 v[48:63], v[172:175], v[16:19], 0
  buffer_load_dwordx4 v[236:239], v14, s[44:47], s14 offen offset:2080 sc1
  s_add_u32 s14, s14, 2816
  v_exp_f32 v64, v64
  v_exp_f32 v65, v65
  v_exp_f32 v66, v66
  v_exp_f32 v67, v67
  v_mfma_f32_32x32x16_bf16 v[112:127], v[162:165], v[4:7], v[112:127]
  s_cmp_eq_u32 s14, s13
  s_cselect_b32 s14, s12, s14
  v_exp_f32 v68, v68
  v_exp_f32 v69, v69
  v_exp_f32 v70, v70
  v_exp_f32 v71, v71
  v_mfma_f32_32x32x8_bf16 v[48:63], v[184:185], v[32:33], v[48:63]
  v_cvt_pk_bf16_f32 v40, v64, v65
  v_cvt_pk_bf16_f32 v41, v66, v67
  v_cvt_pk_bf16_f32 v42, v68, v69
  v_cvt_pk_bf16_f32 v43, v70, v71
  v_exp_f32 v72, v72
  v_exp_f32 v73, v73
  v_exp_f32 v74, v74
  v_exp_f32 v75, v75
  v_mfma_f32_32x32x16_bf16 v[112:127], v[166:169], v[8:11], v[112:127]
  v_exp_f32 v76, v76
  v_exp_f32 v77, v77
  v_exp_f32 v78, v78
  v_exp_f32 v79, v79
  v_cvt_pk_bf16_f32 v44, v72, v73
  v_cvt_pk_bf16_f32 v45, v74, v75
  v_cvt_pk_bf16_f32 v46, v76, v77
  v_cvt_pk_bf16_f32 v47, v78, v79
  v_mfma_f32_32x32x16_bf16 v[64:79], v[172:175], v[20:23], 0
  buffer_load_dwordx4 v[242:245], v12, s[44:47], s14 offen sc1
  v_exp_f32 v48, v48
  v_exp_f32 v49, v49
  v_exp_f32 v50, v50
  v_exp_f32 v51, v51
  v_mfma_f32_32x32x16_bf16 v[128:143], v[162:165], v[40:43], v[128:143]
  buffer_load_dwordx2 v[254:255], v13, s[44:47], s14 offen offset:1024 sc1
  v_exp_f32 v52, v52
  v_exp_f32 v53, v53
  v_exp_f32 v54, v54
  v_exp_f32 v55, v55
  v_mfma_f32_32x32x8_bf16 v[64:79], v[184:185], v[34:35], v[64:79]
  v_cvt_pk_bf16_f32 v4, v48, v49
  v_cvt_pk_bf16_f32 v5, v50, v51
  v_cvt_pk_bf16_f32 v6, v52, v53
  v_cvt_pk_bf16_f32 v7, v54, v55
  v_exp_f32 v56, v56
  v_exp_f32 v57, v57
  v_exp_f32 v58, v58
  v_exp_f32 v59, v59
  v_mfma_f32_32x32x16_bf16 v[128:143], v[166:169], v[44:47], v[128:143]
  buffer_load_dwordx4 v[246:249], v14, s[44:47], s14 offen offset:1408 sc1
  v_exp_f32 v60, v60
  v_exp_f32 v61, v61
  v_exp_f32 v62, v62
  v_exp_f32 v63, v63
  v_cvt_pk_bf16_f32 v8, v56, v57
  v_cvt_pk_bf16_f32 v9, v58, v59
  v_cvt_pk_bf16_f32 v10, v60, v61
  v_cvt_pk_bf16_f32 v11, v62, v63
  v_mfma_f32_32x32x16_bf16 v[48:63], v[172:175], v[24:27], 0
  buffer_load_dwordx4 v[250:253], v14, s[44:47], s14 offen offset:2080 sc1
  s_add_u32 s14, s14, 2816
  v_exp_f32 v64, v64
  v_exp_f32 v65, v65
  v_exp_f32 v66, v66
  v_exp_f32 v67, v67
  v_mfma_f32_32x32x16_bf16 v[80:95], v[176:179], v[4:7], v[80:95]
  s_cmp_eq_u32 s14, s13
  s_cselect_b32 s14, s12, s14
  v_exp_f32 v68, v68
  v_exp_f32 v69, v69
  v_exp_f32 v70, v70
  v_exp_f32 v71, v71
  v_mfma_f32_32x32x8_bf16 v[48:63], v[184:185], v[36:37], v[48:63]
  v_cvt_pk_bf16_f32 v40, v64, v65
  v_cvt_pk_bf16_f32 v41, v66, v67
  v_cvt_pk_bf16_f32 v42, v68, v69
  v_cvt_pk_bf16_f32 v43, v70, v71
  v_exp_f32 v72, v72
  v_exp_f32 v73, v73
  v_exp_f32 v74, v74
  v_exp_f32 v75, v75
  v_mfma_f32_32x32x16_bf16 v[80:95], v[180:183], v[8:11], v[80:95]
  buffer_load_dwordx4 v[144:147], v12, s[44:47], s14 offen sc1
  v_exp_f32 v76, v76
  v_exp_f32 v77, v77
  v_exp_f32 v78, v78
  v_exp_f32 v79, v79
  v_cvt_pk_bf16_f32 v44, v72, v73
  v_cvt_pk_bf16_f32 v45, v74, v75
  v_cvt_pk_bf16_f32 v46, v76, v77
  v_cvt_pk_bf16_f32 v47, v78, v79
  v_mfma_f32_32x32x16_bf16 v[64:79], v[172:175], v[28:31], 0
  buffer_load_dwordx2 v[156:157], v13, s[44:47], s14 offen offset:1024 sc1
  v_exp_f32 v48, v48
  v_exp_f32 v49, v49
  v_exp_f32 v50, v50
  v_exp_f32 v51, v51
  v_mfma_f32_32x32x16_bf16 v[96:111], v[176:179], v[40:43], v[96:111]
  buffer_load_dwordx4 v[148:151], v14, s[44:47], s14 offen offset:1408 sc1
  v_exp_f32 v52, v52
  v_exp_f32 v53, v53
  v_exp_f32 v54, v54
  v_exp_f32 v55, v55
  v_mfma_f32_32x32x8_bf16 v[64:79], v[184:185], v[38:39], v[64:79]
  v_cvt_pk_bf16_f32 v4, v48, v49
  v_cvt_pk_bf16_f32 v5, v50, v51
  v_cvt_pk_bf16_f32 v6, v52, v53
  v_cvt_pk_bf16_f32 v7, v54, v55
  v_exp_f32 v56, v56
  v_exp_f32 v57, v57
  v_exp_f32 v58, v58
  v_exp_f32 v59, v59
  v_mfma_f32_32x32x16_bf16 v[96:111], v[180:183], v[44:47], v[96:111]
  s_waitcnt vmcnt(19)
  v_exp_f32 v60, v60
  v_exp_f32 v61, v61
  v_exp_f32 v62, v62
  v_exp_f32 v63, v63
  v_cvt_pk_bf16_f32 v8, v56, v57
  v_cvt_pk_bf16_f32 v9, v58, v59
  v_cvt_pk_bf16_f32 v10, v60, v61
  v_cvt_pk_bf16_f32 v11, v62, v63
  v_mfma_f32_32x32x16_bf16 v[48:63], v[186:189], v[16:19], 0
  buffer_load_dwordx4 v[152:155], v14, s[44:47], s14 offen offset:2080 sc1
  s_add_u32 s14, s14, 2816
  v_exp_f32 v64, v64
  v_exp_f32 v65, v65
  v_exp_f32 v66, v66
  v_exp_f32 v67, v67
  v_mfma_f32_32x32x16_bf16 v[112:127], v[176:179], v[4:7], v[112:127]
  s_cmp_eq_u32 s14, s13
  s_cselect_b32 s14, s12, s14
  v_exp_f32 v68, v68
  v_exp_f32 v69, v69
  v_exp_f32 v70, v70
  v_exp_f32 v71, v71
  v_mfma_f32_32x32x8_bf16 v[48:63], v[198:199], v[32:33], v[48:63]
  v_cvt_pk_bf16_f32 v40, v64, v65
  v_cvt_pk_bf16_f32 v41, v66, v67
  v_cvt_pk_bf16_f32 v42, v68, v69
  v_cvt_pk_bf16_f32 v43, v70, v71
  v_exp_f32 v72, v72
  v_exp_f32 v73, v73
  v_exp_f32 v74, v74
  v_exp_f32 v75, v75
  v_mfma_f32_32x32x16_bf16 v[112:127], v[180:183], v[8:11], v[112:127]
  v_exp_f32 v76, v76
  v_exp_f32 v77, v77
  v_exp_f32 v78, v78
  v_exp_f32 v79, v79
  v_cvt_pk_bf16_f32 v44, v72, v73
  v_cvt_pk_bf16_f32 v45, v74, v75
  v_cvt_pk_bf16_f32 v46, v76, v77
  v_cvt_pk_bf16_f32 v47, v78, v79
  v_mfma_f32_32x32x16_bf16 v[64:79], v[186:189], v[20:23], 0
  buffer_load_dwordx4 v[158:161], v12, s[44:47], s14 offen sc1
  v_exp_f32 v48, v48
  v_exp_f32 v49, v49
  v_exp_f32 v50, v50
  v_exp_f32 v51, v51
  v_mfma_f32_32x32x16_bf16 v[128:143], v[176:179], v[40:43], v[128:143]
  buffer_load_dwordx2 v[170:171], v13, s[44:47], s14 offen offset:1024 sc1
  v_exp_f32 v52, v52
  v_exp_f32 v53, v53
  v_exp_f32 v54, v54
  v_exp_f32 v55, v55
  v_mfma_f32_32x32x8_bf16 v[64:79], v[198:199], v[34:35], v[64:79]
  v_cvt_pk_bf16_f32 v4, v48, v49
  v_cvt_pk_bf16_f32 v5, v50, v51
  v_cvt_pk_bf16_f32 v6, v52, v53
  v_cvt_pk_bf16_f32 v7, v54, v55
  v_exp_f32 v56, v56
  v_exp_f32 v57, v57
  v_exp_f32 v58, v58
  v_exp_f32 v59, v59
  v_mfma_f32_32x32x16_bf16 v[128:143], v[180:183], v[44:47], v[128:143]
  buffer_load_dwordx4 v[162:165], v14, s[44:47], s14 offen offset:1408 sc1
  v_exp_f32 v60, v60
  v_exp_f32 v61, v61
  v_exp_f32 v62, v62
  v_exp_f32 v63, v63
  v_cvt_pk_bf16_f32 v8, v56, v57
  v_cvt_pk_bf16_f32 v9, v58, v59
  v_cvt_pk_bf16_f32 v10, v60, v61
  v_cvt_pk_bf16_f32 v11, v62, v63
  v_mfma_f32_32x32x16_bf16 v[48:63], v[186:189], v[24:27], 0
  buffer_load_dwordx4 v[166:169], v14, s[44:47], s14 offen offset:2080 sc1
  s_add_u32 s14, s14, 2816
  v_exp_f32 v64, v64
  v_exp_f32 v65, v65
  v_exp_f32 v66, v66
  v_exp_f32 v67, v67
  v_mfma_f32_32x32x16_bf16 v[80:95], v[190:193], v[4:7], v[80:95]
  s_cmp_eq_u32 s14, s13
  s_cselect_b32 s14, s12, s14
  v_exp_f32 v68, v68
  v_exp_f32 v69, v69
  v_exp_f32 v70, v70
  v_exp_f32 v71, v71
  v_mfma_f32_32x32x8_bf16 v[48:63], v[198:199], v[36:37], v[48:63]
  v_cvt_pk_bf16_f32 v40, v64, v65
  v_cvt_pk_bf16_f32 v41, v66, v67
  v_cvt_pk_bf16_f32 v42, v68, v69
  v_cvt_pk_bf16_f32 v43, v70, v71
  v_exp_f32 v72, v72
  v_exp_f32 v73, v73
  v_exp_f32 v74, v74
  v_exp_f32 v75, v75
  v_mfma_f32_32x32x16_bf16 v[80:95], v[194:197], v[8:11], v[80:95]
  buffer_load_dwordx4 v[172:175], v12, s[44:47], s14 offen sc1
  v_exp_f32 v76, v76
  v_exp_f32 v77, v77
  v_exp_f32 v78, v78
  v_exp_f32 v79, v79
  v_cvt_pk_bf16_f32 v44, v72, v73
  v_cvt_pk_bf16_f32 v45, v74, v75
  v_cvt_pk_bf16_f32 v46, v76, v77
  v_cvt_pk_bf16_f32 v47, v78, v79
  v_mfma_f32_32x32x16_bf16 v[64:79], v[186:189], v[28:31], 0
  buffer_load_dwordx2 v[184:185], v13, s[44:47], s14 offen offset:1024 sc1
  v_exp_f32 v48, v48
  v_exp_f32 v49, v49
  v_exp_f32 v50, v50
  v_exp_f32 v51, v51
  v_mfma_f32_32x32x16_bf16 v[96:111], v[190:193], v[40:43], v[96:111]
  buffer_load_dwordx4 v[176:179], v14, s[44:47], s14 offen offset:1408 sc1
  v_exp_f32 v52, v52
  v_exp_f32 v53, v53
  v_exp_f32 v54, v54
  v_exp_f32 v55, v55
  v_mfma_f32_32x32x8_bf16 v[64:79], v[198:199], v[38:39], v[64:79]
  v_cvt_pk_bf16_f32 v4, v48, v49
  v_cvt_pk_bf16_f32 v5, v50, v51
  v_cvt_pk_bf16_f32 v6, v52, v53
  v_cvt_pk_bf16_f32 v7, v54, v55
  v_exp_f32 v56, v56
  v_exp_f32 v57, v57
  v_exp_f32 v58, v58
  v_exp_f32 v59, v59
  v_mfma_f32_32x32x16_bf16 v[96:111], v[194:197], v[44:47], v[96:111]
  s_waitcnt vmcnt(23)
  v_exp_f32 v60, v60
  v_exp_f32 v61, v61
  v_exp_f32 v62, v62
  v_exp_f32 v63, v63
  v_cvt_pk_bf16_f32 v8, v56, v57
  v_cvt_pk_bf16_f32 v9, v58, v59
  v_cvt_pk_bf16_f32 v10, v60, v61
  v_cvt_pk_bf16_f32 v11, v62, v63
  v_mfma_f32_32x32x16_bf16 v[48:63], v[200:203], v[16:19], 0
  buffer_load_dwordx4 v[180:183], v14, s[44:47], s14 offen offset:2080 sc1
  s_add_u32 s14, s14, 2816
  v_exp_f32 v64, v64
  v_exp_f32 v65, v65
  v_exp_f32 v66, v66
  v_exp_f32 v67, v67
  v_mfma_f32_32x32x16_bf16 v[112:127], v[190:193], v[4:7], v[112:127]
  s_cmp_eq_u32 s14, s13
  s_cselect_b32 s14, s12, s14
  v_exp_f32 v68, v68
  v_exp_f32 v69, v69
  v_exp_f32 v70, v70
  v_exp_f32 v71, v71
  v_mfma_f32_32x32x8_bf16 v[48:63], v[212:213], v[32:33], v[48:63]
  v_cvt_pk_bf16_f32 v40, v64, v65
  v_cvt_pk_bf16_f32 v41, v66, v67
  v_cvt_pk_bf16_f32 v42, v68, v69
  v_cvt_pk_bf16_f32 v43, v70, v71
  v_exp_f32 v72, v72
  v_exp_f32 v73, v73
  v_exp_f32 v74, v74
  v_exp_f32 v75, v75
  v_mfma_f32_32x32x16_bf16 v[112:127], v[194:197], v[8:11], v[112:127]
  v_exp_f32 v76, v76
  v_exp_f32 v77, v77
  v_exp_f32 v78, v78
  v_exp_f32 v79, v79
  v_cvt_pk_bf16_f32 v44, v72, v73
  v_cvt_pk_bf16_f32 v45, v74, v75
  v_cvt_pk_bf16_f32 v46, v76, v77
  v_cvt_pk_bf16_f32 v47, v78, v79
  s_branch F_ab4
.p2align 6
F_aloop:
F_ab0:
  v_mfma_f32_32x32x16_bf16 v[64:79], v[144:147], v[20:23], 0
  buffer_load_dwordx4 v[242:245], v12, s[44:47], s14 offen sc1
  v_exp_f32 v48, v48
  v_exp_f32 v49, v49
  v_exp_f32 v50, v50
  v_exp_f32 v51, v51
  v_mfma_f32_32x32x16_bf16 v[128:143], v[246:249], v[40:43], v[128:143]
  v_exp_f32 v52, v52
  v_exp_f32 v53, v53
  v_exp_f32 v54, v54
  v_exp_f32 v55, v55
  v_mfma_f32_32x32x8_bf16 v[64:79], v[156:157], v[34:35], v[64:79]
  v_cvt_pk_bf16_f32 v4, v48, v49
  v_cvt_pk_bf16_f32 v5, v50, v51
  v_cvt_pk_bf16_f32 v6, v52, v53
  v_cvt_pk_bf16_f32 v7, v54, v55
  v_exp_f32 v56, v56
  v_exp_f32 v57, v57
  v_exp_f32 v58, v58
  v_exp_f32 v59, v59
  v_mfma_f32_32x32x16_bf16 v[128:143], v[250:253], v[44:47], v[128:143]
  buffer_load_dwordx2 v[254:255], v13, s[44:47], s14 offen offset:1024 sc1
  v_exp_f32 v60, v60
  v_exp_f32 v61, v61
  v_exp_f32 v62, v62
  v_exp_f32 v63, v63
  v_cvt_pk_bf16_f32 v8, v56, v57
  v_cvt_pk_bf16_f32 v9, v58, v59
  v_cvt_pk_bf16_f32 v10, v60, v61
  v_cvt_pk_bf16_f32 v11, v62, v63
  v_mfma_f32_32x32x16_bf16 v[48:63], v[144:147], v[24:27], 0
  buffer_load_dwordx4 v[246:249], v14, s[44:47], s14 offen offset:1408 sc1
  v_exp_f32 v64, v64
  v_exp_f32 v65, v65
  v_exp_f32 v66, v66
  v_exp_f32 v67, v67
  v_mfma_f32_32x32x16_bf16 v[80:95], v[148:151], v[4:7], v[80:95]
  buffer_load_dwordx4 v[250:253], v14, s[44:47], s14 offen offset:2080 sc1
  v_exp_f32 v68, v68
  v_exp_f32 v69, v69
  v_exp_f32 v70, v70
  v_exp_f32 v71, v71
  v_mfma_f32_32x32x8_bf16 v[48:63], v[156:157], v[36:37], v[48:63]
  v_cvt_pk_bf16_f32 v40, v64, v65
  v_cvt_pk_bf16_f32 v41, v66, v67
  v_cvt_pk_bf16_f32 v42, v68, v69
  v_cvt_pk_bf16_f32 v43, v70, v71
  v_exp_f32 v72, v72
  v_exp_f32 v73, v73
  v_exp_f32 v74, v74
  v_exp_f32 v75, v75
  v_mfma_f32_32x32x16_bf16 v[80:95], v[152:155], v[8:11], v[80:95]
  s_add_u32 s14, s14, 2816
  v_exp_f32 v76, v76
  v_exp_f32 v77, v77
  v_exp_f32 v78, v78
  v_exp_f32 v79, v79
  v_cvt_pk_bf16_f32 v44, v72, v73
  v_cvt_pk_bf16_f32 v45, v74, v75
  v_cvt_pk_bf16_f32 v46, v76, v77
  v_cvt_pk_bf16_f32 v47, v78, v79
  v_mfma_f32_32x32x16_bf16 v[64:79], v[144:147], v[28:31], 0
  s_cmp_eq_u32 s14, s13
  v_exp_f32 v48, v48
  v_exp_f32 v49, v49
  v_exp_f32 v50, v50
  v_exp_f32 v51, v51
  v_mfma_f32_32x32x16_bf16 v[96:111], v[148:151], v[40:43], v[96:111]
  s_cselect_b32 s14, s12, s14
  v_exp_f32 v52, v52
  v_exp_f32 v53, v53
  v_exp_f32 v54, v54
  v_exp_f32 v55, v55
  v_mfma_f32_32x32x8_bf16 v[64:79], v[156:157], v[38:39], v[64:79]
  v_cvt_pk_bf16_f32 v4, v48, v49
  v_cvt_pk_bf16_f32 v5, v50, v51
  v_cvt_pk_bf16_f32 v6, v52, v53
  v_cvt_pk_bf16_f32 v7, v54, v55
  v_exp_f32 v56, v56
  v_exp_f32 v57, v57
  v_exp_f32 v58, v58
  v_exp_f32 v59, v59
  v_mfma_f32_32x32x16_bf16 v[96:111], v[152:155], v[44:47], v[96:111]
  s_waitcnt vmcnt(24)
  v_exp_f32 v60, v60
  v_exp_f32 v61, v61
  v_exp_f32 v62, v62
  v_exp_f32 v63, v63
  v_cvt_pk_bf16_f32 v8, v56, v57
  v_cvt_pk_bf16_f32 v9, v58, v59
  v_cvt_pk_bf16_f32 v10, v60, v61
  v_cvt_pk_bf16_f32 v11, v62, v63
  v_mfma_f32_32x32x16_bf16 v[48:63], v[158:161], v[16:19], 0
  s_cmp_eq_u32 s19, 3
  v_exp_f32 v64, v64
  v_exp_f32 v65, v65
  v_exp_f32 v66, v66
  v_exp_f32 v67, v67
  v_mfma_f32_32x32x16_bf16 v[112:127], v[148:151], v[4:7], v[112:127]
  s_cselect_b32 s46, 0, s46
  v_exp_f32 v68, v68
  v_exp_f32 v69, v69
  v_exp_f32 v70, v70
  v_exp_f32 v71, v71
  v_mfma_f32_32x32x8_bf16 v[48:63], v[170:171], v[32:33], v[48:63]
  v_cvt_pk_bf16_f32 v40, v64, v65
  v_cvt_pk_bf16_f32 v41, v66, v67
  v_cvt_pk_bf16_f32 v42, v68, v69
  v_cvt_pk_bf16_f32 v43, v70, v71
  v_exp_f32 v72, v72
  v_exp_f32 v73, v73
  v_exp_f32 v74, v74
  v_exp_f32 v75, v75
  v_mfma_f32_32x32x16_bf16 v[112:127], v[152:155], v[8:11], v[112:127]
  v_exp_f32 v76, v76
  v_exp_f32 v77, v77
  v_exp_f32 v78, v78
  v_exp_f32 v79, v79
  v_cvt_pk_bf16_f32 v44, v72, v73
  v_cvt_pk_bf16_f32 v45, v74, v75
  v_cvt_pk_bf16_f32 v46, v76, v77
  v_cvt_pk_bf16_f32 v47, v78, v79
F_ab1:
  v_mfma_f32_32x32x16_bf16 v[64:79], v[158:161], v[20:23], 0
  buffer_load_dwordx4 v[144:147], v12, s[44:47], s14 offen sc1
  v_exp_f32 v48, v48
  v_exp_f32 v49, v49
  v_exp_f32 v50, v50
  v_exp_f32 v51, v51
  v_mfma_f32_32x32x16_bf16 v[128:143], v[148:151], v[40:43], v[128:143]
  v_exp_f32 v52, v52
  v_exp_f32 v53, v53
  v_exp_f32 v54, v54
  v_exp_f32 v55, v55
  v_mfma_f32_32x32x8_bf16 v[64:79], v[170:171], v[34:35], v[64:79]
  v_cvt_pk_bf16_f32 v4, v48, v49
  v_cvt_pk_bf16_f32 v5, v50, v51
  v_cvt_pk_bf16_f32 v6, v52, v53
  v_cvt_pk_bf16_f32 v7, v54, v55
  v_exp_f32 v56, v56
  v_exp_f32 v57, v57
  v_exp_f32 v58, v58
  v_exp_f32 v59, v59
  v_mfma_f32_32x32x16_bf16 v[128:143], v[152:155], v[44:47], v[128:143]
  buffer_load_dwordx2 v[156:157], v13, s[44:47], s14 offen offset:1024 sc1
  v_exp_f32 v60, v60
  v_exp_f32 v61, v61
  v_exp_f32 v62, v62
  v_exp_f32 v63, v63
  v_cvt_pk_bf16_f32 v8, v56, v57
  v_cvt_pk_bf16_f32 v9, v58, v59
  v_cvt_pk_bf16_f32 v10, v60, v61
  v_cvt_pk_bf16_f32 v11, v62, v63
  v_mfma_f32_32x32x16_bf16 v[48:63], v[158:161], v[24:27], 0
  buffer_load_dwordx4 v[148:151], v14, s[44:47], s14 offen offset:1408 sc1
  v_exp_f32 v64, v64
  v_exp_f32 v65, v65
  v_exp_f32 v66, v66
  v_exp_f32 v67, v67
  v_mfma_f32_32x32x16_bf16 v[80:95], v[162:165], v[4:7], v[80:95]
  buffer_load_dwordx4 v[152:155], v14, s[44:47], s14 offen offset:2080 sc1
  v_exp_f32 v68, v68
  v_exp_f32 v69, v69
  v_exp_f32 v70, v70
  v_exp_f32 v71, v71
  v_mfma_f32_32x32x8_bf16 v[48:63], v[170:171], v[36:37], v[48:63]
  v_cvt_pk_bf16_f32 v40, v64, v65
  v_cvt_pk_bf16_f32 v41, v66, v67
  v_cvt_pk_bf16_f32 v42, v68, v69
  v_cvt_pk_bf16_f32 v43, v70, v71
  v_exp_f32 v72, v72
  v_exp_f32 v73, v73
  v_exp_f32 v74, v74
  v_exp_f32 v75, v75
  v_mfma_f32_32x32x16_bf16 v[80:95], v[166:169], v[8:11], v[80:95]
  s_add_u32 s14, s14, 2816
  v_exp_f32 v76, v76
  v_exp_f32 v77, v77
  v_exp_f32 v78, v78
  v_exp_f32 v79, v79
  v_cvt_pk_bf16_f32 v44, v72, v73
  v_cvt_pk_bf16_f32 v45, v74, v75
  v_cvt_pk_bf16_f32 v46, v76, v77
  v_cvt_pk_bf16_f32 v47, v78, v79
  v_mfma_f32_32x32x16_bf16 v[64:79], v[158:161], v[28:31], 0
  s_cmp_eq_u32 s14, s13
  v_exp_f32 v48, v48
  v_exp_f32 v49, v49
  v_exp_f32 v50, v50
  v_exp_f32 v51, v51
  v_mfma_f32_32x32x16_bf16 v[96:111], v[162:165], v[40:43], v[96:111]
  s_cselect_b32 s14, s12, s14
  v_exp_f32 v52, v52
  v_exp_f32 v53, v53
  v_exp_f32 v54, v54
  v_exp_f32 v55, v55
  v_mfma_f32_32x32x8_bf16 v[64:79], v[170:171], v[38:39], v[64:79]
  v_cvt_pk_bf16_f32 v4, v48, v49
  v_cvt_pk_bf16_f32 v5, v50, v51
  v_cvt_pk_bf16_f32 v6, v52, v53
  v_cvt_pk_bf16_f32 v7, v54, v55
  v_exp_f32 v56, v56
  v_exp_f32 v57, v57
  v_exp_f32 v58, v58
  v_exp_f32 v59, v59
  v_mfma_f32_32x32x16_bf16 v[96:111], v[166:169], v[44:47], v[96:111]
  s_waitcnt vmcnt(24)
  v_exp_f32 v60, v60
  v_exp_f32 v61, v61
  v_exp_f32 v62, v62
  v_exp_f32 v63, v63
  v_cvt_pk_bf16_f32 v8, v56, v57
  v_cvt_pk_bf16_f32 v9, v58, v59
  v_cvt_pk_bf16_f32 v10, v60, v61
  v_cvt_pk_bf16_f32 v11, v62, v63
  v_mfma_f32_32x32x16_bf16 v[48:63], v[172:175], v[16:19], 0
  v_exp_f32 v64, v64
  v_exp_f32 v65, v65
  v_exp_f32 v66, v66
  v_exp_f32 v67, v67
  v_mfma_f32_32x32x16_bf16 v[112:127], v[162:165], v[4:7], v[112:127]
  v_exp_f32 v68, v68
  v_exp_f32 v69, v69
  v_exp_f32 v70, v70
  v_exp_f32 v71, v71
  v_mfma_f32_32x32x8_bf16 v[48:63], v[184:185], v[32:33], v[48:63]
  v_cvt_pk_bf16_f32 v40, v64, v65
  v_cvt_pk_bf16_f32 v41, v66, v67
  v_cvt_pk_bf16_f32 v42, v68, v69
  v_cvt_pk_bf16_f32 v43, v70, v71
  v_exp_f32 v72, v72
  v_exp_f32 v73, v73
  v_exp_f32 v74, v74
  v_exp_f32 v75, v75
  v_mfma_f32_32x32x16_bf16 v[112:127], v[166:169], v[8:11], v[112:127]
  v_exp_f32 v76, v76
  v_exp_f32 v77, v77
  v_exp_f32 v78, v78
  v_exp_f32 v79, v79
  v_cvt_pk_bf16_f32 v44, v72, v73
  v_cvt_pk_bf16_f32 v45, v74, v75
  v_cvt_pk_bf16_f32 v46, v76, v77
  v_cvt_pk_bf16_f32 v47, v78, v79
F_ab2:
  v_mfma_f32_32x32x16_bf16 v[64:79], v[172:175], v[20:23], 0
  buffer_load_dwordx4 v[158:161], v12, s[44:47], s14 offen sc1
  v_exp_f32 v48, v48
  v_exp_f32 v49, v49
  v_exp_f32 v50, v50
  v_exp_f32 v51, v51
  v_mfma_f32_32x32x16_bf16 v[128:143], v[162:165], v[40:43], v[128:143]
  v_exp_f32 v52, v52
  v_exp_f32 v53, v53
  v_exp_f32 v54, v54
  v_exp_f32 v55, v55
  v_mfma_f32_32x32x8_bf16 v[64:79], v[184:185], v[34:35], v[64:79]
  v_cvt_pk_bf16_f32 v4, v48, v49
  v_cvt_pk_bf16_f32 v5, v50, v51
  v_cvt_pk_bf16_f32 v6, v52, v53
  v_cvt_pk_bf16_f32 v7, v54, v55
  v_exp_f32 v56, v56
  v_exp_f32 v57, v57
  v_exp_f32 v58, v58
  v_exp_f32 v59, v59
  v_mfma_f32_32x32x16_bf16 v[128:143], v[166:169], v[44:47], v[128:143]
  buffer_load_dwordx2 v[170:171], v13, s[44:47], s14 offen offset:1024 sc1
  v_exp_f32 v60, v60
  v_exp_f32 v61, v61
  v_exp_f32 v62, v62
  v_exp_f32 v63, v63
  v_cvt_pk_bf16_f32 v8, v56, v57
  v_cvt_pk_bf16_f32 v9, v58, v59
  v_cvt_pk_bf16_f32 v10, v60, v61
  v_cvt_pk_bf16_f32 v11, v62, v63
  v_mfma_f32_32x32x16_bf16 v[48:63], v[172:175], v[24:27], 0
  buffer_load_dwordx4 v[162:165], v14, s[44:47], s14 offen offset:1408 sc1
  v_exp_f32 v64, v64
  v_exp_f32 v65, v65
  v_exp_f32 v66, v66
  v_exp_f32 v67, v67
  v_mfma_f32_32x32x16_bf16 v[80:95], v[176:179], v[4:7], v[80:95]
  buffer_load_dwordx4 v[166:169], v14, s[44:47], s14 offen offset:2080 sc1
  v_exp_f32 v68, v68
  v_exp_f32 v69, v69
  v_exp_f32 v70, v70
  v_exp_f32 v71, v71
  v_mfma_f32_32x32x8_bf16 v[48:63], v[184:185], v[36:37], v[48:63]
  v_cvt_pk_bf16_f32 v40, v64, v65
  v_cvt_pk_bf16_f32 v41, v66, v67
  v_cvt_pk_bf16_f32 v42, v68, v69
  v_cvt_pk_bf16_f32 v43, v70, v71
  v_exp_f32 v72, v72
  v_exp_f32 v73, v73
  v_exp_f32 v74, v74
  v_exp_f32 v75, v75
  v_mfma_f32_32x32x16_bf16 v[80:95], v[180:183], v[8:11], v[80:95]
  s_add_u32 s14, s14, 2816
  v_exp_f32 v76, v76
  v_exp_f32 v77, v77
  v_exp_f32 v78, v78
  v_exp_f32 v79, v79
  v_cvt_pk_bf16_f32 v44, v72, v73
  v_cvt_pk_bf16_f32 v45, v74, v75
  v_cvt_pk_bf16_f32 v46, v76, v77
  v_cvt_pk_bf16_f32 v47, v78, v79
  v_mfma_f32_32x32x16_bf16 v[64:79], v[172:175], v[28:31], 0
  s_cmp_eq_u32 s14, s13
  v_exp_f32 v48, v48
  v_exp_f32 v49, v49
  v_exp_f32 v50, v50
  v_exp_f32 v51, v51
  v_mfma_f32_32x32x16_bf16 v[96:111], v[176:179], v[40:43], v[96:111]
  s_cselect_b32 s14, s12, s14
  v_exp_f32 v52, v52
  v_exp_f32 v53, v53
  v_exp_f32 v54, v54
  v_exp_f32 v55, v55
  v_mfma_f32_32x32x8_bf16 v[64:79], v[184:185], v[38:39], v[64:79]
  v_cvt_pk_bf16_f32 v4, v48, v49
  v_cvt_pk_bf16_f32 v5, v50, v51
  v_cvt_pk_bf16_f32 v6, v52, v53
  v_cvt_pk_bf16_f32 v7, v54, v55
  v_exp_f32 v56, v56
  v_exp_f32 v57, v57
  v_exp_f32 v58, v58
  v_exp_f32 v59, v59
  v_mfma_f32_32x32x16_bf16 v[96:111], v[180:183], v[44:47], v[96:111]
  s_waitcnt vmcnt(24)
  v_exp_f32 v60, v60
  v_exp_f32 v61, v61
  v_exp_f32 v62, v62
  v_exp_f32 v63, v63
  v_cvt_pk_bf16_f32 v8, v56, v57
  v_cvt_pk_bf16_f32 v9, v58, v59
  v_cvt_pk_bf16_f32 v10, v60, v61
  v_cvt_pk_bf16_f32 v11, v62, v63
  v_mfma_f32_32x32x16_bf16 v[48:63], v[186:189], v[16:19], 0
  v_exp_f32 v64, v64
  v_exp_f32 v65, v65
  v_exp_f32 v66, v66
  v_exp_f32 v67, v67
  v_mfma_f32_32x32x16_bf16 v[112:127], v[176:179], v[4:7], v[112:127]
  v_exp_f32 v68, v68
  v_exp_f32 v69, v69
  v_exp_f32 v70, v70
  v_exp_f32 v71, v71
  v_mfma_f32_32x32x8_bf16 v[48:63], v[198:199], v[32:33], v[48:63]
  v_cvt_pk_bf16_f32 v40, v64, v65
  v_cvt_pk_bf16_f32 v41, v66, v67
  v_cvt_pk_bf16_f32 v42, v68, v69
  v_cvt_pk_bf16_f32 v43, v70, v71
  v_exp_f32 v72, v72
  v_exp_f32 v73, v73
  v_exp_f32 v74, v74
  v_exp_f32 v75, v75
  v_mfma_f32_32x32x16_bf16 v[112:127], v[180:183], v[8:11], v[112:127]
  v_exp_f32 v76, v76
  v_exp_f32 v77, v77
  v_exp_f32 v78, v78
  v_exp_f32 v79, v79
  v_cvt_pk_bf16_f32 v44, v72, v73
  v_cvt_pk_bf16_f32 v45, v74, v75
  v_cvt_pk_bf16_f32 v46, v76, v77
  v_cvt_pk_bf16_f32 v47, v78, v79
F_ab3:
  v_mfma_f32_32x32x16_bf16 v[64:79], v[186:189], v[20:23], 0
  buffer_load_dwordx4 v[172:175], v12, s[44:47], s14 offen sc1
  v_exp_f32 v48, v48
  v_exp_f32 v49, v49
  v_exp_f32 v50, v50
  v_exp_f32 v51, v51
  v_mfma_f32_32x32x16_bf16 v[128:143], v[176:179], v[40:43], v[128:143]
  v_exp_f32 v52, v52
  v_exp_f32 v53, v53
  v_exp_f32 v54, v54
  v_exp_f32 v55, v55
  v_mfma_f32_32x32x8_bf16 v[64:79], v[198:199], v[34:35], v[64:79]
  v_cvt_pk_bf16_f32 v4, v48, v49
  v_cvt_pk_bf16_f32 v5, v50, v51
  v_cvt_pk_bf16_f32 v6, v52, v53
  v_cvt_pk_bf16_f32 v7, v54, v55
  v_exp_f32 v56, v56
  v_exp_f32 v57, v57
  v_exp_f32 v58, v58
  v_exp_f32 v59, v59
  v_mfma_f32_32x32x16_bf16 v[128:143], v[180:183], v[44:47], v[128:143]
  buffer_load_dwordx2 v[184:185], v13, s[44:47], s14 offen offset:1024 sc1
  v_exp_f32 v60, v60
  v_exp_f32 v61, v61
  v_exp_f32 v62, v62
  v_exp_f32 v63, v63
  v_cvt_pk_bf16_f32 v8, v56, v57
  v_cvt_pk_bf16_f32 v9, v58, v59
  v_cvt_pk_bf16_f32 v10, v60, v61
  v_cvt_pk_bf16_f32 v11, v62, v63
  v_mfma_f32_32x32x16_bf16 v[48:63], v[186:189], v[24:27], 0
  buffer_load_dwordx4 v[176:179], v14, s[44:47], s14 offen offset:1408 sc1
  v_exp_f32 v64, v64
  v_exp_f32 v65, v65
  v_exp_f32 v66, v66
  v_exp_f32 v67, v67
  v_mfma_f32_32x32x16_bf16 v[80:95], v[190:193], v[4:7], v[80:95]
  buffer_load_dwordx4 v[180:183], v14, s[44:47], s14 offen offset:2080 sc1
  v_exp_f32 v68, v68
  v_exp_f32 v69, v69
  v_exp_f32 v70, v70
  v_exp_f32 v71, v71
  v_mfma_f32_32x32x8_bf16 v[48:63], v[198:199], v[36:37], v[48:63]
  v_cvt_pk_bf16_f32 v40, v64, v65
  v_cvt_pk_bf16_f32 v41, v66, v67
  v_cvt_pk_bf16_f32 v42, v68, v69
  v_cvt_pk_bf16_f32 v43, v70, v71
  v_exp_f32 v72, v72
  v_exp_f32 v73, v73
  v_exp_f32 v74, v74
  v_exp_f32 v75, v75
  v_mfma_f32_32x32x16_bf16 v[80:95], v[194:197], v[8:11], v[80:95]
  s_add_u32 s14, s14, 2816
  v_exp_f32 v76, v76
  v_exp_f32 v77, v77
  v_exp_f32 v78, v78
  v_exp_f32 v79, v79
  v_cvt_pk_bf16_f32 v44, v72, v73
  v_cvt_pk_bf16_f32 v45, v74, v75
  v_cvt_pk_bf16_f32 v46, v76, v77
  v_cvt_pk_bf16_f32 v47, v78, v79
  v_mfma_f32_32x32x16_bf16 v[64:79], v[186:189], v[28:31], 0
  s_cmp_eq_u32 s14, s13
  v_exp_f32 v48, v48
  v_exp_f32 v49, v49
  v_exp_f32 v50, v50
  v_exp_f32 v51, v51
  v_mfma_f32_32x32x16_bf16 v[96:111], v[190:193], v[40:43], v[96:111]
  s_cselect_b32 s14, s12, s14
  v_exp_f32 v52, v52
  v_exp_f32 v53, v53
  v_exp_f32 v54, v54
  v_exp_f32 v55, v55
  v_mfma_f32_32x32x8_bf16 v[64:79], v[198:199], v[38:39], v[64:79]
  v_cvt_pk_bf16_f32 v4, v48, v49
  v_cvt_pk_bf16_f32 v5, v50, v51
  v_cvt_pk_bf16_f32 v6, v52, v53
  v_cvt_pk_bf16_f32 v7, v54, v55
  v_exp_f32 v56, v56
  v_exp_f32 v57, v57
  v_exp_f32 v58, v58
  v_exp_f32 v59, v59
  v_mfma_f32_32x32x16_bf16 v[96:111], v[194:197], v[44:47], v[96:111]
  s_waitcnt vmcnt(24)
  v_exp_f32 v60, v60
  v_exp_f32 v61, v61
  v_exp_f32 v62, v62
  v_exp_f32 v63, v63
  v_cvt_pk_bf16_f32 v8, v56, v57
  v_cvt_pk_bf16_f32 v9, v58, v59
  v_cvt_pk_bf16_f32 v10, v60, v61
  v_cvt_pk_bf16_f32 v11, v62, v63
  v_mfma_f32_32x32x16_bf16 v[48:63], v[200:203], v[16:19], 0
  v_exp_f32 v64, v64
  v_exp_f32 v65, v65
  v_exp_f32 v66, v66
  v_exp_f32 v67, v67
  v_mfma_f32_32x32x16_bf16 v[112:127], v[190:193], v[4:7], v[112:127]
  v_exp_f32 v68, v68
  v_exp_f32 v69, v69
  v_exp_f32 v70, v70
  v_exp_f32 v71, v71
  v_mfma_f32_32x32x8_bf16 v[48:63], v[212:213], v[32:33], v[48:63]
  v_cvt_pk_bf16_f32 v40, v64, v65
  v_cvt_pk_bf16_f32 v41, v66, v67
  v_cvt_pk_bf16_f32 v42, v68, v69
  v_cvt_pk_bf16_f32 v43, v70, v71
  v_exp_f32 v72, v72
  v_exp_f32 v73, v73
  v_exp_f32 v74, v74
  v_exp_f32 v75, v75
  v_mfma_f32_32x32x16_bf16 v[112:127], v[194:197], v[8:11], v[112:127]
  v_exp_f32 v76, v76
  v_exp_f32 v77, v77
  v_exp_f32 v78, v78
  v_exp_f32 v79, v79
  v_cvt_pk_bf16_f32 v44, v72, v73
  v_cvt_pk_bf16_f32 v45, v74, v75
  v_cvt_pk_bf16_f32 v46, v76, v77
  v_cvt_pk_bf16_f32 v47, v78, v79
F_ab4:
  v_mfma_f32_32x32x16_bf16 v[64:79], v[200:203], v[20:23], 0
  buffer_load_dwordx4 v[186:189], v12, s[44:47], s14 offen sc1
  v_exp_f32 v48, v48
  v_exp_f32 v49, v49
  v_exp_f32 v50, v50
  v_exp_f32 v51, v51
  v_mfma_f32_32x32x16_bf16 v[128:143], v[190:193], v[40:43], v[128:143]
  v_exp_f32 v52, v52
  v_exp_f32 v53, v53
  v_exp_f32 v54, v54
  v_exp_f32 v55, v55
  v_mfma_f32_32x32x8_bf16 v[64:79], v[212:213], v[34:35], v[64:79]
  v_cvt_pk_bf16_f32 v4, v48, v49
  v_cvt_pk_bf16_f32 v5, v50, v51
  v_cvt_pk_bf16_f32 v6, v52, v53
  v_cvt_pk_bf16_f32 v7, v54, v55
  v_exp_f32 v56, v56
  v_exp_f32 v57, v57
  v_exp_f32 v58, v58
  v_exp_f32 v59, v59
  v_mfma_f32_32x32x16_bf16 v[128:143], v[194:197], v[44:47], v[128:143]
  buffer_load_dwordx2 v[198:199], v13, s[44:47], s14 offen offset:1024 sc1
  v_exp_f32 v60, v60
  v_exp_f32 v61, v61
  v_exp_f32 v62, v62
  v_exp_f32 v63, v63
  v_cvt_pk_bf16_f32 v8, v56, v57
  v_cvt_pk_bf16_f32 v9, v58, v59
  v_cvt_pk_bf16_f32 v10, v60, v61
  v_cvt_pk_bf16_f32 v11, v62, v63
  v_mfma_f32_32x32x16_bf16 v[48:63], v[200:203], v[24:27], 0
  buffer_load_dwordx4 v[190:193], v14, s[44:47], s14 offen offset:1408 sc1
  v_exp_f32 v64, v64
  v_exp_f32 v65, v65
  v_exp_f32 v66, v66
  v_exp_f32 v67, v67
  v_mfma_f32_32x32x16_bf16 v[80:95], v[204:207], v[4:7], v[80:95]
  buffer_load_dwordx4 v[194:197], v14, s[44:47], s14 offen offset:2080 sc1
  v_exp_f32 v68, v68
  v_exp_f32 v69, v69
  v_exp_f32 v70, v70
  v_exp_f32 v71, v71
  v_mfma_f32_32x32x8_bf16 v[48:63], v[212:213], v[36:37], v[48:63]
  v_cvt_pk_bf16_f32 v40, v64, v65
  v_cvt_pk_bf16_f32 v41, v66, v67
  v_cvt_pk_bf16_f32 v42, v68, v69
  v_cvt_pk_bf16_f32 v43, v70, v71
  v_exp_f32 v72, v72
  v_exp_f32 v73, v73
  v_exp_f32 v74, v74
  v_exp_f32 v75, v75
  v_mfma_f32_32x32x16_bf16 v[80:95], v[208:211], v[8:11], v[80:95]
  s_add_u32 s14, s14, 2816
  v_exp_f32 v76, v76
  v_exp_f32 v77, v77
  v_exp_f32 v78, v78
  v_exp_f32 v79, v79
  v_cvt_pk_bf16_f32 v44, v72, v73
  v_cvt_pk_bf16_f32 v45, v74, v75
  v_cvt_pk_bf16_f32 v46, v76, v77
  v_cvt_pk_bf16_f32 v47, v78, v79
  v_mfma_f32_32x32x16_bf16 v[64:79], v[200:203], v[28:31], 0
  s_cmp_eq_u32 s14, s13
  v_exp_f32 v48, v48
  v_exp_f32 v49, v49
  v_exp_f32 v50, v50
  v_exp_f32 v51, v51
  v_mfma_f32_32x32x16_bf16 v[96:111], v[204:207], v[40:43], v[96:111]
  s_cselect_b32 s14, s12, s14
  v_exp_f32 v52, v52
  v_exp_f32 v53, v53
  v_exp_f32 v54, v54
  v_exp_f32 v55, v55
  v_mfma_f32_32x32x8_bf16 v[64:79], v[212:213], v[38:39], v[64:79]
  v_cvt_pk_bf16_f32 v4, v48, v49
  v_cvt_pk_bf16_f32 v5, v50, v51
  v_cvt_pk_bf16_f32 v6, v52, v53
  v_cvt_pk_bf16_f32 v7, v54, v55
  v_exp_f32 v56, v56
  v_exp_f32 v57, v57
  v_exp_f32 v58, v58
  v_exp_f32 v59, v59
  v_mfma_f32_32x32x16_bf16 v[96:111], v[208:211], v[44:47], v[96:111]
  s_waitcnt vmcnt(24)
  v_exp_f32 v60, v60
  v_exp_f32 v61, v61
  v_exp_f32 v62, v62
  v_exp_f32 v63, v63
  v_cvt_pk_bf16_f32 v8, v56, v57
  v_cvt_pk_bf16_f32 v9, v58, v59
  v_cvt_pk_bf16_f32 v10, v60, v61
  v_cvt_pk_bf16_f32 v11, v62, v63
  v_mfma_f32_32x32x16_bf16 v[48:63], v[214:217], v[16:19], 0
  v_exp_f32 v64, v64
  v_exp_f32 v65, v65
  v_exp_f32 v66, v66
  v_exp_f32 v67, v67
  v_mfma_f32_32x32x16_bf16 v[112:127], v[204:207], v[4:7], v[112:127]
  v_exp_f32 v68, v68
  v_exp_f32 v69, v69
  v_exp_f32 v70, v70
  v_exp_f32 v71, v71
  v_mfma_f32_32x32x8_bf16 v[48:63], v[226:227], v[32:33], v[48:63]
  v_cvt_pk_bf16_f32 v40, v64, v65
  v_cvt_pk_bf16_f32 v41, v66, v67
  v_cvt_pk_bf16_f32 v42, v68, v69
  v_cvt_pk_bf16_f32 v43, v70, v71
  v_exp_f32 v72, v72
  v_exp_f32 v73, v73
  v_exp_f32 v74, v74
  v_exp_f32 v75, v75
  v_mfma_f32_32x32x16_bf16 v[112:127], v[208:211], v[8:11], v[112:127]
  v_exp_f32 v76, v76
  v_exp_f32 v77, v77
  v_exp_f32 v78, v78
  v_exp_f32 v79, v79
  v_cvt_pk_bf16_f32 v44, v72, v73
  v_cvt_pk_bf16_f32 v45, v74, v75
  v_cvt_pk_bf16_f32 v46, v76, v77
  v_cvt_pk_bf16_f32 v47, v78, v79
F_ab5:
  v_mfma_f32_32x32x16_bf16 v[64:79], v[214:217], v[20:23], 0
  buffer_load_dwordx4 v[200:203], v12, s[44:47], s14 offen sc1
  v_exp_f32 v48, v48
  v_exp_f32 v49, v49
  v_exp_f32 v50, v50
  v_exp_f32 v51, v51
  v_mfma_f32_32x32x16_bf16 v[128:143], v[204:207], v[40:43], v[128:143]
  v_exp_f32 v52, v52
  v_exp_f32 v53, v53
  v_exp_f32 v54, v54
  v_exp_f32 v55, v55
  v_mfma_f32_32x32x8_bf16 v[64:79], v[226:227], v[34:35], v[64:79]
  v_cvt_pk_bf16_f32 v4, v48, v49
  v_cvt_pk_bf16_f32 v5, v50, v51
  v_cvt_pk_bf16_f32 v6, v52, v53
  v_cvt_pk_bf16_f32 v7, v54, v55
  v_exp_f32 v56, v56
  v_exp_f32 v57, v57
  v_exp_f32 v58, v58
  v_exp_f32 v59, v59
  v_mfma_f32_32x32x16_bf16 v[128:143], v[208:211], v[44:47], v[128:143]
  buffer_load_dwordx2 v[212:213], v13, s[44:47], s14 offen offset:1024 sc1
  v_exp_f32 v60, v60
  v_exp_f32 v61, v61
  v_exp_f32 v62, v62
  v_exp_f32 v63, v63
  v_cvt_pk_bf16_f32 v8, v56, v57
  v_cvt_pk_bf16_f32 v9, v58, v59
  v_cvt_pk_bf16_f32 v10, v60, v61
  v_cvt_pk_bf16_f32 v11, v62, v63
  v_mfma_f32_32x32x16_bf16 v[48:63], v[214:217], v[24:27], 0
  buffer_load_dwordx4 v[204:207], v14, s[44:47], s14 offen offset:1408 sc1
  v_exp_f32 v64, v64
  v_exp_f32 v65, v65
  v_exp_f32 v66, v66
  v_exp_f32 v67, v67
  v_mfma_f32_32x32x16_bf16 v[80:95], v[218:221], v[4:7], v[80:95]
  buffer_load_dwordx4 v[208:211], v14, s[44:47], s14 offen offset:2080 sc1
  v_exp_f32 v68, v68
  v_exp_f32 v69, v69
  v_exp_f32 v70, v70
  v_exp_f32 v71, v71
  v_mfma_f32_32x32x8_bf16 v[48:63], v[226:227], v[36:37], v[48:63]
  v_cvt_pk_bf16_f32 v40, v64, v65
  v_cvt_pk_bf16_f32 v41, v66, v67
  v_cvt_pk_bf16_f32 v42, v68, v69
  v_cvt_pk_bf16_f32 v43, v70, v71
  v_exp_f32 v72, v72
  v_exp_f32 v73, v73
  v_exp_f32 v74, v74
  v_exp_f32 v75, v75
  v_mfma_f32_32x32x16_bf16 v[80:95], v[222:225], v[8:11], v[80:95]
  s_add_u32 s14, s14, 2816
  v_exp_f32 v76, v76
  v_exp_f32 v77, v77
  v_exp_f32 v78, v78
  v_exp_f32 v79, v79
  v_cvt_pk_bf16_f32 v44, v72, v73
  v_cvt_pk_bf16_f32 v45, v74, v75
  v_cvt_pk_bf16_f32 v46, v76, v77
  v_cvt_pk_bf16_f32 v47, v78, v79
  v_mfma_f32_32x32x16_bf16 v[64:79], v[214:217], v[28:31], 0
  s_cmp_eq_u32 s14, s13
  v_exp_f32 v48, v48
  v_exp_f32 v49, v49
  v_exp_f32 v50, v50
  v_exp_f32 v51, v51
  v_mfma_f32_32x32x16_bf16 v[96:111], v[218:221], v[40:43], v[96:111]
  s_cselect_b32 s14, s12, s14
  v_exp_f32 v52, v52
  v_exp_f32 v53, v53
  v_exp_f32 v54, v54
  v_exp_f32 v55, v55
  v_mfma_f32_32x32x8_bf16 v[64:79], v[226:227], v[38:39], v[64:79]
  v_cvt_pk_bf16_f32 v4, v48, v49
  v_cvt_pk_bf16_f32 v5, v50, v51
  v_cvt_pk_bf16_f32 v6, v52, v53
  v_cvt_pk_bf16_f32 v7, v54, v55
  v_exp_f32 v56, v56
  v_exp_f32 v57, v57
  v_exp_f32 v58, v58
  v_exp_f32 v59, v59
  v_mfma_f32_32x32x16_bf16 v[96:111], v[222:225], v[44:47], v[96:111]
  s_waitcnt vmcnt(24)
  v_exp_f32 v60, v60
  v_exp_f32 v61, v61
  v_exp_f32 v62, v62
  v_exp_f32 v63, v63
  v_cvt_pk_bf16_f32 v8, v56, v57
  v_cvt_pk_bf16_f32 v9, v58, v59
  v_cvt_pk_bf16_f32 v10, v60, v61
  v_cvt_pk_bf16_f32 v11, v62, v63
  v_mfma_f32_32x32x16_bf16 v[48:63], v[228:231], v[16:19], 0
  v_exp_f32 v64, v64
  v_exp_f32 v65, v65
  v_exp_f32 v66, v66
  v_exp_f32 v67, v67
  v_mfma_f32_32x32x16_bf16 v[112:127], v[218:221], v[4:7], v[112:127]
  v_exp_f32 v68, v68
  v_exp_f32 v69, v69
  v_exp_f32 v70, v70
  v_exp_f32 v71, v71
  v_mfma_f32_32x32x8_bf16 v[48:63], v[240:241], v[32:33], v[48:63]
  v_cvt_pk_bf16_f32 v40, v64, v65
  v_cvt_pk_bf16_f32 v41, v66, v67
  v_cvt_pk_bf16_f32 v42, v68, v69
  v_cvt_pk_bf16_f32 v43, v70, v71
  v_exp_f32 v72, v72
  v_exp_f32 v73, v73
  v_exp_f32 v74, v74
  v_exp_f32 v75, v75
  v_mfma_f32_32x32x16_bf16 v[112:127], v[222:225], v[8:11], v[112:127]
  v_exp_f32 v76, v76
  v_exp_f32 v77, v77
  v_exp_f32 v78, v78
  v_exp_f32 v79, v79
  v_cvt_pk_bf16_f32 v44, v72, v73
  v_cvt_pk_bf16_f32 v45, v74, v75
  v_cvt_pk_bf16_f32 v46, v76, v77
  v_cvt_pk_bf16_f32 v47, v78, v79
F_ab6:
  v_mfma_f32_32x32x16_bf16 v[64:79], v[228:231], v[20:23], 0
  buffer_load_dwordx4 v[214:217], v12, s[44:47], s14 offen sc1
  v_exp_f32 v48, v48
  v_exp_f32 v49, v49
  v_exp_f32 v50, v50
  v_exp_f32 v51, v51
  v_mfma_f32_32x32x16_bf16 v[128:143], v[218:221], v[40:43], v[128:143]
  v_exp_f32 v52, v52
  v_exp_f32 v53, v53
  v_exp_f32 v54, v54
  v_exp_f32 v55, v55
  v_mfma_f32_32x32x8_bf16 v[64:79], v[240:241], v[34:35], v[64:79]
  v_cvt_pk_bf16_f32 v4, v48, v49
  v_cvt_pk_bf16_f32 v5, v50, v51
  v_cvt_pk_bf16_f32 v6, v52, v53
  v_cvt_pk_bf16_f32 v7, v54, v55
  v_exp_f32 v56, v56
  v_exp_f32 v57, v57
  v_exp_f32 v58, v58
  v_exp_f32 v59, v59
  v_mfma_f32_32x32x16_bf16 v[128:143], v[222:225], v[44:47], v[128:143]
  buffer_load_dwordx2 v[226:227], v13, s[44:47], s14 offen offset:1024 sc1
  v_exp_f32 v60, v60
  v_exp_f32 v61, v61
  v_exp_f32 v62, v62
  v_exp_f32 v63, v63
  v_cvt_pk_bf16_f32 v8, v56, v57
  v_cvt_pk_bf16_f32 v9, v58, v59
  v_cvt_pk_bf16_f32 v10, v60, v61
  v_cvt_pk_bf16_f32 v11, v62, v63
  v_mfma_f32_32x32x16_bf16 v[48:63], v[228:231], v[24:27], 0
  buffer_load_dwordx4 v[218:221], v14, s[44:47], s14 offen offset:1408 sc1
  v_exp_f32 v64, v64
  v_exp_f32 v65, v65
  v_exp_f32 v66, v66
  v_exp_f32 v67, v67
  v_mfma_f32_32x32x16_bf16 v[80:95], v[232:235], v[4:7], v[80:95]
  buffer_load_dwordx4 v[222:225], v14, s[44:47], s14 offen offset:2080 sc1
  v_exp_f32 v68, v68
  v_exp_f32 v69, v69
  v_exp_f32 v70, v70
  v_exp_f32 v71, v71
  v_mfma_f32_32x32x8_bf16 v[48:63], v[240:241], v[36:37], v[48:63]
  v_cvt_pk_bf16_f32 v40, v64, v65
  v_cvt_pk_bf16_f32 v41, v66, v67
  v_cvt_pk_bf16_f32 v42, v68, v69
  v_cvt_pk_bf16_f32 v43, v70, v71
  v_exp_f32 v72, v72
  v_exp_f32 v73, v73
  v_exp_f32 v74, v74
  v_exp_f32 v75, v75
  v_mfma_f32_32x32x16_bf16 v[80:95], v[236:239], v[8:11], v[80:95]
  s_add_u32 s14, s14, 2816
  v_exp_f32 v76, v76
  v_exp_f32 v77, v77
  v_exp_f32 v78, v78
  v_exp_f32 v79, v79
  v_cvt_pk_bf16_f32 v44, v72, v73
  v_cvt_pk_bf16_f32 v45, v74, v75
  v_cvt_pk_bf16_f32 v46, v76, v77
  v_cvt_pk_bf16_f32 v47, v78, v79
  v_mfma_f32_32x32x16_bf16 v[64:79], v[228:231], v[28:31], 0
  s_cmp_eq_u32 s14, s13
  v_exp_f32 v48, v48
  v_exp_f32 v49, v49
  v_exp_f32 v50, v50
  v_exp_f32 v51, v51
  v_mfma_f32_32x32x16_bf16 v[96:111], v[232:235], v[40:43], v[96:111]
  s_cselect_b32 s14, s12, s14
  v_exp_f32 v52, v52
  v_exp_f32 v53, v53
  v_exp_f32 v54, v54
  v_exp_f32 v55, v55
  v_mfma_f32_32x32x8_bf16 v[64:79], v[240:241], v[38:39], v[64:79]
  v_cvt_pk_bf16_f32 v4, v48, v49
  v_cvt_pk_bf16_f32 v5, v50, v51
  v_cvt_pk_bf16_f32 v6, v52, v53
  v_cvt_pk_bf16_f32 v7, v54, v55
  v_exp_f32 v56, v56
  v_exp_f32 v57, v57
  v_exp_f32 v58, v58
  v_exp_f32 v59, v59
  v_mfma_f32_32x32x16_bf16 v[96:111], v[236:239], v[44:47], v[96:111]
  s_waitcnt vmcnt(24)
  v_exp_f32 v60, v60
  v_exp_f32 v61, v61
  v_exp_f32 v62, v62
  v_exp_f32 v63, v63
  v_cvt_pk_bf16_f32 v8, v56, v57
  v_cvt_pk_bf16_f32 v9, v58, v59
  v_cvt_pk_bf16_f32 v10, v60, v61
  v_cvt_pk_bf16_f32 v11, v62, v63
  v_mfma_f32_32x32x16_bf16 v[48:63], v[242:245], v[16:19], 0
  v_exp_f32 v64, v64
  v_exp_f32 v65, v65
  v_exp_f32 v66, v66
  v_exp_f32 v67, v67
  v_mfma_f32_32x32x16_bf16 v[112:127], v[232:235], v[4:7], v[112:127]
  s_cmp_eq_u32 s46, 0
  v_exp_f32 v68, v68
  v_exp_f32 v69, v69
  v_exp_f32 v70, v70
  v_exp_f32 v71, v71
  v_mfma_f32_32x32x8_bf16 v[48:63], v[254:255], v[32:33], v[48:63]
  v_cvt_pk_bf16_f32 v40, v64, v65
  v_cvt_pk_bf16_f32 v41, v66, v67
  v_cvt_pk_bf16_f32 v42, v68, v69
  v_cvt_pk_bf16_f32 v43, v70, v71
  v_exp_f32 v72, v72
  v_exp_f32 v73, v73
  v_exp_f32 v74, v74
  v_exp_f32 v75, v75
  v_mfma_f32_32x32x16_bf16 v[112:127], v[236:239], v[8:11], v[112:127]
  v_exp_f32 v76, v76
  v_exp_f32 v77, v77
  v_exp_f32 v78, v78
  v_exp_f32 v79, v79
  v_cvt_pk_bf16_f32 v44, v72, v73
  v_cvt_pk_bf16_f32 v45, v74, v75
  v_cvt_pk_bf16_f32 v46, v76, v77
  v_cvt_pk_bf16_f32 v47, v78, v79
  s_cbranch_scc1 F_alast
F_ab7:
  v_mfma_f32_32x32x16_bf16 v[64:79], v[242:245], v[20:23], 0
  buffer_load_dwordx4 v[228:231], v12, s[44:47], s14 offen sc1
  v_exp_f32 v48, v48
  v_exp_f32 v49, v49
  v_exp_f32 v50, v50
  v_exp_f32 v51, v51
  v_mfma_f32_32x32x16_bf16 v[128:143], v[232:235], v[40:43], v[128:143]
  v_exp_f32 v52, v52
  v_exp_f32 v53, v53
  v_exp_f32 v54, v54
  v_exp_f32 v55, v55
  v_mfma_f32_32x32x8_bf16 v[64:79], v[254:255], v[34:35], v[64:79]
  v_cvt_pk_bf16_f32 v4, v48, v49
  v_cvt_pk_bf16_f32 v5, v50, v51
  v_cvt_pk_bf16_f32 v6, v52, v53
  v_cvt_pk_bf16_f32 v7, v54, v55
  v_exp_f32 v56, v56
  v_exp_f32 v57, v57
  v_exp_f32 v58, v58
  v_exp_f32 v59, v59
  v_mfma_f32_32x32x16_bf16 v[128:143], v[236:239], v[44:47], v[128:143]
  buffer_load_dwordx2 v[240:241], v13, s[44:47], s14 offen offset:1024 sc1
  v_exp_f32 v60, v60
  v_exp_f32 v61, v61
  v_exp_f32 v62, v62
  v_exp_f32 v63, v63
  v_cvt_pk_bf16_f32 v8, v56, v57
  v_cvt_pk_bf16_f32 v9, v58, v59
  v_cvt_pk_bf16_f32 v10, v60, v61
  v_cvt_pk_bf16_f32 v11, v62, v63
  v_mfma_f32_32x32x16_bf16 v[48:63], v[242:245], v[24:27], 0
  buffer_load_dwordx4 v[232:235], v14, s[44:47], s14 offen offset:1408 sc1
  v_exp_f32 v64, v64
  v_exp_f32 v65, v65
  v_exp_f32 v66, v66
  v_exp_f32 v67, v67
  v_mfma_f32_32x32x16_bf16 v[80:95], v[246:249], v[4:7], v[80:95]
  buffer_load_dwordx4 v[236:239], v14, s[44:47], s14 offen offset:2080 sc1
  v_exp_f32 v68, v68
  v_exp_f32 v69, v69
  v_exp_f32 v70, v70
  v_exp_f32 v71, v71
  v_mfma_f32_32x32x8_bf16 v[48:63], v[254:255], v[36:37], v[48:63]
  v_cvt_pk_bf16_f32 v40, v64, v65
  v_cvt_pk_bf16_f32 v41, v66, v67
  v_cvt_pk_bf16_f32 v42, v68, v69
  v_cvt_pk_bf16_f32 v43, v70, v71
  v_exp_f32 v72, v72
  v_exp_f32 v73, v73
  v_exp_f32 v74, v74
  v_exp_f32 v75, v75
  v_mfma_f32_32x32x16_bf16 v[80:95], v[250:253], v[8:11], v[80:95]
  s_add_u32 s14, s14, 2816
  v_exp_f32 v76, v76
  v_exp_f32 v77, v77
  v_exp_f32 v78, v78
  v_exp_f32 v79, v79
  v_cvt_pk_bf16_f32 v44, v72, v73
  v_cvt_pk_bf16_f32 v45, v74, v75
  v_cvt_pk_bf16_f32 v46, v76, v77
  v_cvt_pk_bf16_f32 v47, v78, v79
  v_mfma_f32_32x32x16_bf16 v[64:79], v[242:245], v[28:31], 0
  s_cmp_eq_u32 s14, s13
  v_exp_f32 v48, v48
  v_exp_f32 v49, v49
  v_exp_f32 v50, v50
  v_exp_f32 v51, v51
  v_mfma_f32_32x32x16_bf16 v[96:111], v[246:249], v[40:43], v[96:111]
  s_cselect_b32 s14, s12, s14
  v_exp_f32 v52, v52
  v_exp_f32 v53, v53
  v_exp_f32 v54, v54
  v_exp_f32 v55, v55
  v_mfma_f32_32x32x8_bf16 v[64:79], v[254:255], v[38:39], v[64:79]
  v_cvt_pk_bf16_f32 v4, v48, v49
  v_cvt_pk_bf16_f32 v5, v50, v51
  v_cvt_pk_bf16_f32 v6, v52, v53
  v_cvt_pk_bf16_f32 v7, v54, v55
  v_exp_f32 v56, v56
  v_exp_f32 v57, v57
  v_exp_f32 v58, v58
  v_exp_f32 v59, v59
  v_mfma_f32_32x32x16_bf16 v[96:111], v[250:253], v[44:47], v[96:111]
  s_waitcnt vmcnt(24)
  v_exp_f32 v60, v60
  v_exp_f32 v61, v61
  v_exp_f32 v62, v62
  v_exp_f32 v63, v63
  v_cvt_pk_bf16_f32 v8, v56, v57
  v_cvt_pk_bf16_f32 v9, v58, v59
  v_cvt_pk_bf16_f32 v10, v60, v61
  v_cvt_pk_bf16_f32 v11, v62, v63
  v_mfma_f32_32x32x16_bf16 v[48:63], v[144:147], v[16:19], 0
  s_add_u32 s19, s19, 1
  v_exp_f32 v64, v64
  v_exp_f32 v65, v65
  v_exp_f32 v66, v66
  v_exp_f32 v67, v67
  v_mfma_f32_32x32x16_bf16 v[112:127], v[246:249], v[4:7], v[112:127]
  v_exp_f32 v68, v68
  v_exp_f32 v69, v69
  v_exp_f32 v70, v70
  v_exp_f32 v71, v71
  v_mfma_f32_32x32x8_bf16 v[48:63], v[156:157], v[32:33], v[48:63]
  v_cvt_pk_bf16_f32 v40, v64, v65
  v_cvt_pk_bf16_f32 v41, v66, v67
  v_cvt_pk_bf16_f32 v42, v68, v69
  v_cvt_pk_bf16_f32 v43, v70, v71
  v_exp_f32 v72, v72
  v_exp_f32 v73, v73
  v_exp_f32 v74, v74
  v_exp_f32 v75, v75
  v_mfma_f32_32x32x16_bf16 v[112:127], v[250:253], v[8:11], v[112:127]
  v_exp_f32 v76, v76
  v_exp_f32 v77, v77
  v_exp_f32 v78, v78
  v_exp_f32 v79, v79
  v_cvt_pk_bf16_f32 v44, v72, v73
  v_cvt_pk_bf16_f32 v45, v74, v75
  v_cvt_pk_bf16_f32 v46, v76, v77
  v_cvt_pk_bf16_f32 v47, v78, v79
  s_branch F_aloop
F_alast:
  v_mfma_f32_32x32x16_bf16 v[64:79], v[242:245], v[20:23], 0
  v_exp_f32 v48, v48
  v_exp_f32 v49, v49
  v_exp_f32 v50, v50
  v_exp_f32 v51, v51
  v_mfma_f32_32x32x16_bf16 v[128:143], v[232:235], v[40:43], v[128:143]
  v_exp_f32 v52, v52
  v_exp_f32 v53, v53
  v_exp_f32 v54, v54
  v_exp_f32 v55, v55
  v_mfma_f32_32x32x8_bf16 v[64:79], v[254:255], v[34:35], v[64:79]
  v_cvt_pk_bf16_f32 v4, v48, v49
  v_cvt_pk_bf16_f32 v5, v50, v51
  v_cvt_pk_bf16_f32 v6, v52, v53
  v_cvt_pk_bf16_f32 v7, v54, v55
  v_exp_f32 v56, v56
  v_exp_f32 v57, v57
  v_exp_f32 v58, v58
  v_exp_f32 v59, v59
  v_mfma_f32_32x32x16_bf16 v[128:143], v[236:239], v[44:47], v[128:143]
  v_exp_f32 v60, v60
  v_exp_f32 v61, v61
  v_exp_f32 v62, v62
  v_exp_f32 v63, v63
  v_cvt_pk_bf16_f32 v8, v56, v57
  v_cvt_pk_bf16_f32 v9, v58, v59
  v_cvt_pk_bf16_f32 v10, v60, v61
  v_cvt_pk_bf16_f32 v11, v62, v63
  v_mfma_f32_32x32x16_bf16 v[48:63], v[242:245], v[24:27], 0
  s_waitcnt vmcnt(0)
  v_exp_f32 v64, v64
  v_exp_f32 v65, v65
  v_exp_f32 v66, v66
  v_exp_f32 v67, v67
  v_mfma_f32_32x32x16_bf16 v[80:95], v[246:249], v[4:7], v[80:95]
  v_add_u32 v144, s29, v12
  v_add_u32 v145, s30, v12
  v_mov_b32 v148, 161792
  v_exp_f32 v68, v68
  v_exp_f32 v69, v69
  v_exp_f32 v70, v70
  v_exp_f32 v71, v71
  v_mfma_f32_32x32x8_bf16 v[48:63], v[254:255], v[36:37], v[48:63]
  v_cvt_pk_bf16_f32 v40, v64, v65
  v_cvt_pk_bf16_f32 v41, v66, v67
  v_cvt_pk_bf16_f32 v42, v68, v69
  v_cvt_pk_bf16_f32 v43, v70, v71
  v_exp_f32 v72, v72
  v_exp_f32 v73, v73
  v_exp_f32 v74, v74
  v_exp_f32 v75, v75
  v_mfma_f32_32x32x16_bf16 v[80:95], v[250:253], v[8:11], v[80:95]
  v_mov_b32 v146, s31
  v_xor_b32 v147, 8, v146
  v_exp_f32 v76, v76
  v_exp_f32 v77, v77
  v_exp_f32 v78, v78
  v_exp_f32 v79, v79
  v_cvt_pk_bf16_f32 v44, v72, v73
  v_cvt_pk_bf16_f32 v45, v74, v75
  v_cvt_pk_bf16_f32 v46, v76, v77
  v_cvt_pk_bf16_f32 v47, v78, v79
  v_mfma_f32_32x32x16_bf16 v[64:79], v[242:245], v[28:31], 0
  v_exp_f32 v48, v48
  v_exp_f32 v49, v49
  v_exp_f32 v50, v50
  v_exp_f32 v51, v51
  v_mfma_f32_32x32x16_bf16 v[96:111], v[246:249], v[40:43], v[96:111]
  ds_read_b32 v149, v148 offset:76
  v_exp_f32 v52, v52
  v_exp_f32 v53, v53
  v_exp_f32 v54, v54
  v_exp_f32 v55, v55
  v_mfma_f32_32x32x8_bf16 v[64:79], v[254:255], v[38:39], v[64:79]
  v_cvt_pk_bf16_f32 v4, v48, v49
  v_cvt_pk_bf16_f32 v5, v50, v51
  v_cvt_pk_bf16_f32 v6, v52, v53
  v_cvt_pk_bf16_f32 v7, v54, v55
  v_exp_f32 v56, v56
  v_exp_f32 v57, v57
  v_exp_f32 v58, v58
  v_exp_f32 v59, v59
  v_mfma_f32_32x32x16_bf16 v[96:111], v[250:253], v[44:47], v[96:111]
  v_exp_f32 v60, v60
  v_exp_f32 v61, v61
  v_exp_f32 v62, v62
  v_exp_f32 v63, v63
  v_cvt_pk_bf16_f32 v8, v56, v57
  v_cvt_pk_bf16_f32 v9, v58, v59
  v_cvt_pk_bf16_f32 v10, v60, v61
  v_cvt_pk_bf16_f32 v11, v62, v63
  s_waitcnt lgkmcnt(0)
  v_readfirstlane_b32 s3, v149
  s_cmp_ge_u32 s3, 4
  s_cbranch_scc1 F_ceok

  v_mov_b32 v148, 161792
  s_mov_b32 s4, 0
F_l5:
  ds_read_b32 v149, v148 offset:76
  s_add_u32 s4, s4, 1
  s_waitcnt lgkmcnt(0)
  v_readfirstlane_b32 s3, v149
  s_cmp_ge_u32 s3, 4
  s_cbranch_scc1 F_l5_ok

  s_sleep 1
  s_cmp_lt_u32 s4, 1600000
  s_cbranch_scc1 F_l5

F_l5_ok:
F_ceok:

  ds_write_b128 v144, v[80:83] offset:0
  ds_write_b128 v144, v[84:87] offset:1024
  ds_write_b128 v144, v[88:91] offset:2048
  v_exp_f32 v64, v64
  v_exp_f32 v65, v65
  v_exp_f32 v66, v66
  v_exp_f32 v67, v67
  v_mfma_f32_32x32x16_bf16 v[112:127], v[246:249], v[4:7], v[112:127]
  ds_read_b32 v15, v15
  v_exp_f32 v68, v68
  v_exp_f32 v69, v69
  v_exp_f32 v70, v70
  v_exp_f32 v71, v71

  v_cvt_pk_bf16_f32 v40, v64, v65
  v_cvt_pk_bf16_f32 v41, v66, v67
  v_cvt_pk_bf16_f32 v42, v68, v69
  v_cvt_pk_bf16_f32 v43, v70, v71
  v_exp_f32 v72, v72
  v_exp_f32 v73, v73
  v_exp_f32 v74, v74
  v_exp_f32 v75, v75
  v_mfma_f32_32x32x16_bf16 v[112:127], v[250:253], v[8:11], v[112:127]
  ds_write_b128 v144, v[96:99] offset:3072
  ds_write_b128 v144, v[100:103] offset:4096
  ds_write_b128 v144, v[104:107] offset:5120
  ds_write_b32 v147, v147
  v_exp_f32 v76, v76
  v_exp_f32 v77, v77
  v_exp_f32 v78, v78
  v_exp_f32 v79, v79
  v_cvt_pk_bf16_f32 v44, v72, v73
  v_cvt_pk_bf16_f32 v45, v74, v75
  v_cvt_pk_bf16_f32 v46, v76, v77
  v_cvt_pk_bf16_f32 v47, v78, v79
  v_and_b32 v10, 15, v1
  v_lshrrev_b32 v11, 4, v1
  v_mfma_f32_32x32x16_bf16 v[128:143], v[246:249], v[40:43], v[128:143]
  v_mfma_f32_32x32x16_bf16 v[128:143], v[250:253], v[44:47], v[128:143]
  s_setprio 3

  s_mov_b32 s4, 0
F_bb1:
  ds_read_b32 v4, v146
  ds_read_b128 v[80:83], v145 offset:0
  ds_read_b128 v[84:87], v145 offset:1024
  ds_read_b128 v[88:91], v145 offset:2048
  ds_read_b128 v[92:95], v145 offset:3072
  ds_read_b128 v[96:99], v145 offset:4096
  ds_read_b128 v[100:103], v145 offset:5120
  s_add_u32 s4, s4, 1
  s_waitcnt lgkmcnt(6)
  v_readfirstlane_b32 s3, v4
  s_cmp_lg_u32 s3, 0
  s_cbranch_scc1 F_bb2
  s_sleep 1
  s_cmp_lt_u32 s4, 1600000
  s_cbranch_scc1 F_bb1

F_bb2:
  v_mov_b64 v[6:7], 0
  s_waitcnt lgkmcnt(3)
  v_pk_add_f32 v[120:121], v[120:121], v[88:89]
  v_pk_add_f32 v[112:113], v[112:113], v[80:81]
  v_pk_add_f32 v[114:115], v[114:115], v[82:83]
  v_pk_add_f32 v[116:117], v[116:117], v[84:85]
  v_pk_add_f32 v[118:119], v[118:119], v[86:87]
  v_pk_add_f32 v[122:123], v[122:123], v[90:91]
  v_mov_b32 v4, v120
  v_mov_b32 v5, v120
  v_pk_fma_f32 v[6:7], v[112:113], 0, v[6:7]
  v_pk_fma_f32 v[6:7], v[114:115], 0, v[6:7]
  v_permlane32_swap_b32 v4, v5
  v_pk_fma_f32 v[6:7], v[116:117], 0, v[6:7]
  v_pk_fma_f32 v[6:7], v[118:119], 0, v[6:7]
  v_rcp_f32 v4, v5
  v_pk_fma_f32 v[6:7], v[120:121], 0, v[6:7]
  v_pk_fma_f32 v[6:7], v[122:123], 0, v[6:7]
  s_waitcnt lgkmcnt(0)
  v_pk_add_f32 v[136:137], v[136:137], v[100:101]
  v_pk_add_f32 v[128:129], v[128:129], v[92:93]
  v_pk_add_f32 v[130:131], v[130:131], v[94:95]
  v_pk_add_f32 v[132:133], v[132:133], v[96:97]
  v_pk_add_f32 v[134:135], v[134:135], v[98:99]
  v_pk_add_f32 v[138:139], v[138:139], v[102:103]
  v_mov_b32 v8, v136
  v_mov_b32 v9, v136
  v_pk_fma_f32 v[6:7], v[128:129], 0, v[6:7]
  v_pk_fma_f32 v[6:7], v[130:131], 0, v[6:7]
  v_permlane32_swap_b32 v8, v9
  v_pk_fma_f32 v[6:7], v[132:133], 0, v[6:7]
  v_pk_fma_f32 v[6:7], v[134:135], 0, v[6:7]
  v_rcp_f32 v8, v9
  v_pk_fma_f32 v[6:7], v[136:137], 0, v[6:7]
  v_pk_fma_f32 v[6:7], v[138:139], 0, v[6:7]
  s_mov_b32 s41, 0
  v_add_f32 v6, v6, v7
  v_mul_f32 v4, v4, v15
  v_add_f32 v5, v6, v5
  v_add_f32 v9, v6, v9
  v_mul_f32 v8, v8, v15
  v_cmp_nlt_f32 vcc, 0x21800000, v5
  v_cmp_ngt_f32 s[4:5], s42, v5
  s_or_b64 s[4:5], s[4:5], vcc
  v_cmp_nlt_f32 vcc, 0x21800000, v9
  v_cmp_ngt_f32 s[18:19], s42, v9
  s_or_b64 s[4:5], s[4:5], vcc
  s_or_b64 s[4:5], s[4:5], s[18:19]
  s_cbranch_scc1 F_finm

  v_pk_mul_f32 v[112:113], v[112:113], v[4:5] op_sel_hi:[1,0]
  v_pk_mul_f32 v[114:115], v[114:115], v[4:5] op_sel_hi:[1,0]
  v_pk_mul_f32 v[116:117], v[116:117], v[4:5] op_sel_hi:[1,0]
  v_pk_mul_f32 v[118:119], v[118:119], v[4:5] op_sel_hi:[1,0]
  v_pk_mul_f32 v[120:121], v[120:121], v[4:5] op_sel_hi:[1,0]
  v_pk_mul_f32 v[122:123], v[122:123], v[4:5] op_sel_hi:[1,0]
  v_cvt_pk_bf16_f32 v112, v112, v113
  v_cvt_pk_bf16_f32 v113, v114, v115
  v_cvt_pk_bf16_f32 v114, v116, v117
  v_cvt_pk_bf16_f32 v115, v118, v119
  v_min_u32 v112, -2, v112
  v_min_u32 v113, -2, v113
  v_min_u32 v114, -2, v114
  v_min_u32 v115, -2, v115
  buffer_store_dwordx4 v[112:115], v12, s[48:51], s37 offen offset:0 sc1
  v_cvt_pk_bf16_f32 v120, v120, v121
  v_cvt_pk_bf16_f32 v121, v122, v123
  v_pk_mul_f32 v[128:129], v[128:129], v[8:9] op_sel_hi:[1,0]
  v_pk_mul_f32 v[130:131], v[130:131], v[8:9] op_sel_hi:[1,0]
  v_pk_mul_f32 v[132:133], v[132:133], v[8:9] op_sel_hi:[1,0]
  v_pk_mul_f32 v[134:135], v[134:135], v[8:9] op_sel_hi:[1,0]
  v_pk_mul_f32 v[136:137], v[136:137], v[8:9] op_sel_hi:[1,0]
  v_pk_mul_f32 v[138:139], v[138:139], v[8:9] op_sel_hi:[1,0]
  v_cvt_pk_bf16_f32 v116, v128, v129
  v_cvt_pk_bf16_f32 v117, v130, v131
  v_cvt_pk_bf16_f32 v118, v132, v133
  v_cvt_pk_bf16_f32 v119, v134, v135
  v_min_u32 v116, -2, v116
  v_min_u32 v117, -2, v117
  v_min_u32 v118, -2, v118
  v_min_u32 v119, -2, v119
  buffer_store_dwordx4 v[116:119], v12, s[48:51], s37 offen offset:1024 sc1
  v_cvt_pk_bf16_f32 v122, v136, v137
  v_cvt_pk_bf16_f32 v123, v138, v139
  v_min_u32 v120, -2, v120
  v_min_u32 v121, -2, v121
  v_min_u32 v122, -2, v122
  v_min_u32 v123, -2, v123
  s_branch F_fin2
F_finm:
  v_mov_b64 v[80:81], v[112:113]
  v_mov_b64 v[96:97], v[128:129]
  v_mov_b64 v[82:83], v[114:115]
  v_mov_b64 v[98:99], v[130:131]
  v_mov_b64 v[84:85], v[116:117]
  v_mov_b64 v[100:101], v[132:133]
  v_mov_b64 v[86:87], v[118:119]
  v_mov_b64 v[102:103], v[134:135]
  v_mov_b64 v[88:89], v[120:121]
  v_mov_b64 v[104:105], v[136:137]
  v_mov_b64 v[90:91], v[122:123]
  v_mov_b64 v[106:107], v[138:139]
  v_mov_b64 v[16:17], v[24:25]
  v_mov_b64 v[18:19], v[26:27]
  v_mov_b64 v[20:21], v[28:29]
  v_mov_b64 v[22:23], v[30:31]
  v_mov_b64 v[32:33], v[36:37]
  v_mov_b64 v[34:35], v[38:39]
F_fin0:
  s_mov_b32 s43, 0
F_final:
  v_mov_b32 v4, v88
  v_mov_b32 v5, v88
  v_mov_b32 v6, 0
  v_mov_b32 v7, 0
  v_permlane32_swap_b32 v4, v5

  v_fma_f32 v6, v80, v7, v6
  v_fma_f32 v6, v81, v7, v6
  v_fma_f32 v6, v82, v7, v6
  v_fma_f32 v6, v83, v7, v6
  v_fma_f32 v6, v84, v7, v6
  v_fma_f32 v6, v85, v7, v6
  v_fma_f32 v6, v86, v7, v6
  v_fma_f32 v6, v87, v7, v6
  v_fma_f32 v6, v88, v7, v6
  v_fma_f32 v6, v89, v7, v6
  v_fma_f32 v6, v90, v7, v6
  v_fma_f32 v6, v91, v7, v6
  v_add_f32 v6, v6, v5
  v_cmp_nlt_f32 vcc, 0x21800000, v6
  v_cmp_ngt_f32 s[4:5], s42, v6
  s_or_b64 s[4:5], s[4:5], vcc
  s_cmp_eq_u64 s[4:5], 0
  s_cbranch_scc1 F_norm
  s_cmp_lg_u32 s43, 0
  s_cbranch_scc0 F_slow

F_norm:
  v_rcp_f32 v5, v5
  s_nop 0
  v_mul_f32 v5, v5, v15

  v_mul_f32 v80, v5, v80
  v_mul_f32 v81, v5, v81
  v_mul_f32 v82, v5, v82
  v_mul_f32 v83, v5, v83
  v_mul_f32 v84, v5, v84
  v_mul_f32 v85, v5, v85
  v_mul_f32 v86, v5, v86
  v_mul_f32 v87, v5, v87
  v_mul_f32 v88, v5, v88
  v_mul_f32 v89, v5, v89
  v_mul_f32 v90, v5, v90
  v_mul_f32 v91, v5, v91
  s_cmp_lg_u32 s41, 0
  s_cbranch_scc1 F_fin1
  v_cvt_pk_bf16_f32 v112, v80, v81
  v_cvt_pk_bf16_f32 v113, v82, v83
  v_cvt_pk_bf16_f32 v114, v84, v85
  v_cvt_pk_bf16_f32 v115, v86, v87
  v_cvt_pk_bf16_f32 v120, v88, v89
  v_cvt_pk_bf16_f32 v121, v90, v91
  v_min_u32 v112, -2, v112
  v_min_u32 v113, -2, v113
  v_min_u32 v114, -2, v114
  v_min_u32 v115, -2, v115
  v_min_u32 v120, -2, v120
  v_min_u32 v121, -2, v121
  buffer_store_dwordx4 v[112:115], v12, s[48:51], s37 offen sc1
  v_mov_b32 v80, v96
  v_mov_b32 v81, v97
  v_mov_b32 v82, v98
  v_mov_b32 v83, v99
  v_mov_b32 v84, v100
  v_mov_b32 v85, v101
  v_mov_b32 v86, v102
  v_mov_b32 v87, v103
  v_mov_b32 v88, v104
  v_mov_b32 v89, v105
  v_mov_b32 v90, v106
  v_mov_b32 v91, v107
  v_mov_b32 v16, v20
  v_mov_b32 v17, v21
  v_mov_b32 v18, v22
  v_mov_b32 v19, v23
  v_mov_b32 v32, v34
  v_mov_b32 v33, v35
  s_mov_b32 s41, 1
  s_branch F_fin0
F_fin1:
  v_cvt_pk_bf16_f32 v116, v80, v81
  v_cvt_pk_bf16_f32 v117, v82, v83
  v_cvt_pk_bf16_f32 v118, v84, v85
  v_cvt_pk_bf16_f32 v119, v86, v87
  v_cvt_pk_bf16_f32 v122, v88, v89
  v_cvt_pk_bf16_f32 v123, v90, v91
  v_min_u32 v116, -2, v116
  v_min_u32 v117, -2, v117
  v_min_u32 v118, -2, v118
  v_min_u32 v119, -2, v119
  v_min_u32 v122, -2, v122
  v_min_u32 v123, -2, v123
  buffer_store_dwordx4 v[116:119], v12, s[48:51], s37 offen offset:1024 sc1
F_fin2:
  s_mov_b32 exec_hi, 0
  buffer_store_dwordx4 v[120:123], v12, s[48:51], s40 offen sc1
  s_mov_b32 exec_hi, -1

  s_mov_b32 s100, 102400
  s_call_b64 s[98:99], F_gsetup
  s_and_b32 s3, s8, 0
  s_mul_i32 s3, s3, 20480
  s_add_u32 s22, s21, s3

  v_mov_b64 v[24:25], 0
  v_mov_b64 v[26:27], 0
  v_mov_b64 v[28:29], 0
  v_mov_b64 v[30:31], 0
  v_mov_b64 v[32:33], 0
  v_mov_b64 v[34:35], 0
  v_mov_b64 v[36:37], 0
  v_mov_b64 v[38:39], 0
  v_mov_b64 v[40:41], 0
  v_mov_b64 v[42:43], 0
  v_mov_b32 v9, 161792
  s_mov_b32 s4, 0
F_l6:
  ds_read_b32 v8, v9 offset:112
  s_add_u32 s4, s4, 1
  s_waitcnt lgkmcnt(0)
  v_readfirstlane_b32 s3, v8
  s_cmp_ge_u32 s3, 4
  s_cbranch_scc1 F_l6_ok

  s_sleep 1
  s_cmp_lt_u32 s4, 1600000
  s_cbranch_scc1 F_l6

F_l6_ok:
  s_call_b64 s[98:99], F_wpre
  v_mov_b32 v8, 161792
  v_mov_b32 v9, 1
  s_mov_b64 exec, 1
  ds_add_u32 v8, v9 offset:72
  s_mov_b64 exec, -1

  s_branch F_phaseC0
F_slow:
  s_mov_b32 s43, 1
  s_mov_b32 exec_lo, 0
  v_mov_b32 v32, 0
  v_mov_b32 v33, 0
  s_mov_b32 exec_lo, -1
  v_mov_b32 v8, 0xff800000
  s_mov_b32 s14, 7864320

F_sl1:
  buffer_load_dwordx4 v[144:147], v12, s[48:51], s14 offen sc1
  buffer_load_dwordx2 v[156:157], v13, s[48:51], s14 offen offset:1024 sc1
  s_waitcnt vmcnt(0)
  v_mfma_f32_32x32x16_bf16 v[48:63], v[144:147], v[16:19], 0
  v_mfma_f32_32x32x8_bf16 v[48:63], v[156:157], v[32:33], v[48:63]
  s_nop 7
  s_nop 7

  v_max3_f32 v8, v8, v48, v49
  v_max3_f32 v8, v8, v50, v51
  v_max3_f32 v8, v8, v52, v53
  v_max3_f32 v8, v8, v54, v55
  v_max3_f32 v8, v8, v56, v57
  v_max3_f32 v8, v8, v58, v59
  v_max3_f32 v8, v8, v60, v61
  v_max3_f32 v8, v8, v62, v63
  s_add_u32 s14, s14, 2816
  s_cmp_lt_u32 s14, 8044544
  s_cbranch_scc1 F_sl1
  v_mov_b32 v9, v8
  s_nop 1
  v_permlane32_swap_b32 v8, v9
  s_nop 1
  v_max_f32 v8, v8, v9
  v_sub_f32 v8, 0, v8
  v_and_b32 v4, 0xffff0000, v8
  v_sub_f32 v8, v8, v4
  v_and_b32 v5, 0xffff0000, v8
  v_sub_f32 v8, v8, v5
  s_mov_b32 exec_lo, 0
  v_lshrrev_b32 v4, 16, v4
  v_or_b32 v32, v4, v5
  v_lshrrev_b32 v33, 16, v8
  s_mov_b32 exec_lo, -1
  s_mov_b32 s14, 7864320

  v_mov_b32 v80, 0
  v_mov_b32 v81, 0
  v_mov_b32 v82, 0
  v_mov_b32 v83, 0
  v_mov_b32 v84, 0
  v_mov_b32 v85, 0
  v_mov_b32 v86, 0
  v_mov_b32 v87, 0
  v_mov_b32 v88, 0
  v_mov_b32 v89, 0
  v_mov_b32 v90, 0
  v_mov_b32 v91, 0
  v_mov_b32 v92, 0
  v_mov_b32 v93, 0
  v_mov_b32 v94, 0
  v_mov_b32 v95, 0
F_sl2:
  buffer_load_dwordx4 v[144:147], v12, s[48:51], s14 offen sc1
  buffer_load_dwordx2 v[156:157], v13, s[48:51], s14 offen offset:1024 sc1
  buffer_load_dwordx4 v[148:151], v14, s[48:51], s14 offen offset:1408 sc1
  buffer_load_dwordx4 v[152:155], v14, s[48:51], s14 offen offset:2080 sc1
  s_waitcnt vmcnt(0)
  v_mfma_f32_32x32x16_bf16 v[48:63], v[144:147], v[16:19], 0
  v_mfma_f32_32x32x8_bf16 v[48:63], v[156:157], v[32:33], v[48:63]
  s_nop 7
  s_nop 7

  v_exp_f32 v48, v48
  v_exp_f32 v49, v49
  v_exp_f32 v50, v50
  v_exp_f32 v51, v51
  v_exp_f32 v52, v52
  v_exp_f32 v53, v53
  v_exp_f32 v54, v54
  v_exp_f32 v55, v55
  v_exp_f32 v56, v56
  v_exp_f32 v57, v57
  v_exp_f32 v58, v58
  v_exp_f32 v59, v59
  v_exp_f32 v60, v60
  v_exp_f32 v61, v61
  v_exp_f32 v62, v62
  v_exp_f32 v63, v63
  s_nop 0
  v_cvt_pk_bf16_f32 v40, v48, v49
  v_cvt_pk_bf16_f32 v41, v50, v51
  v_cvt_pk_bf16_f32 v42, v52, v53
  v_cvt_pk_bf16_f32 v43, v54, v55
  v_cvt_pk_bf16_f32 v44, v56, v57
  v_cvt_pk_bf16_f32 v45, v58, v59
  v_cvt_pk_bf16_f32 v46, v60, v61
  v_cvt_pk_bf16_f32 v47, v62, v63
  s_nop 1
  v_mfma_f32_32x32x16_bf16 v[80:95], v[148:151], v[40:43], v[80:95]
  v_mfma_f32_32x32x16_bf16 v[80:95], v[152:155], v[44:47], v[80:95]
  s_add_u32 s14, s14, 2816
  s_cmp_lt_u32 s14, 8044544
  s_cbranch_scc1 F_sl2
  s_nop 7
  s_nop 7
  s_branch F_final

F_hsetup:
  v_lshrrev_b32 v4, 1, v3
  v_and_b32 v4, 7, v4
  v_xor_b32 v4, v4, v2
  v_lshlrev_b32 v5, 7, v3

  v_xor_b32 v6, 0, v4
  v_lshl_add_u32 v12, v6, 4, v5
  v_xor_b32 v6, 2, v4
  v_lshl_add_u32 v13, v6, 4, v5
  v_xor_b32 v6, 4, v4
  v_lshl_add_u32 v14, v6, 4, v5
  v_xor_b32 v6, 6, v4
  v_lshl_add_u32 v15, v6, 4, v5
  s_sub_u32 s5, s9, 4
  s_lshl_b32 s3, s8, 9
  s_lshl_b32 s4, s5, 7
  s_add_u32 s3, s3, s4
  v_lshrrev_b32 v4, 3, v1
  v_and_b32 v5, 7, v1
  v_lshlrev_b32 v243, 7, v5
  v_lshlrev_b32 v6, 1, v4
  v_and_b32 v6, 4, v6
  v_xor_b32 v5, v5, v6
  v_mul_u32_u24 v4, 3840, v4
  v_lshl_add_u32 v4, v5, 4, v4
  v_add_u32 v236, s3, v4
  v_add_u32 v237, 30720, v236
  v_add_u32 v238, 61440, v236
  v_add_u32 v239, 92160, v236
  s_lshl_b32 s3, s5, 13
  s_add_u32 s3, s3, 122880
  v_bfe_u32 v4, v1, 2, 2
  v_lshl_add_u32 v5, v2, 3, v4
  v_lshlrev_b32 v5, 7, v5
  v_and_b32 v6, 3, v1
  v_lshl_add_u32 v5, v6, 3, v5
  v_bfe_u32 v6, v1, 4, 1
  v_lshl_add_u32 v5, v6, 5, v5
  v_add_u32 v5, s3, v5
  v_lshrrev_b32 v4, 1, v4
  v_lshlrev_b32 v4, 6, v4
  v_add_u32 v240, v5, v4
  v_xor_b32 v4, 64, v4
  v_add_u32 v241, v5, v4
  v_lshlrev_b32 v153, 4, v10
  v_lshl_add_u32 v154, v6, 9, v153
  v_lshl_add_u32 v154, v2, 8, v154
  s_cmp_eq_u32 s7, 0
  s_cselect_b32 s3, 0, 6144
  v_mul_u32_u24 v5, s3, v2
  v_add_u32 v242, v243, v5

  v_mov_b64 v[172:173], 0
  v_mov_b64 v[174:175], 0
  v_mov_b64 v[176:177], 0
  v_mov_b64 v[178:179], 0
  v_mov_b64 v[180:181], 0
  v_mov_b64 v[182:183], 0
  v_mov_b64 v[184:185], 0
  v_mov_b64 v[186:187], 0
  v_mov_b64 v[188:189], 0
  v_mov_b64 v[190:191], 0
  v_mov_b64 v[192:193], 0
  v_mov_b64 v[194:195], 0
  v_mov_b64 v[196:197], 0
  v_mov_b64 v[198:199], 0
  v_mov_b64 v[200:201], 0
  v_mov_b64 v[202:203], 0
  v_mov_b64 v[204:205], 0
  v_mov_b64 v[206:207], 0
  v_mov_b64 v[208:209], 0
  v_mov_b64 v[210:211], 0
  v_mov_b64 v[212:213], 0
  v_mov_b64 v[214:215], 0
  v_mov_b64 v[216:217], 0
  v_mov_b64 v[218:219], 0
  v_mov_b64 v[220:221], 0
  v_mov_b64 v[222:223], 0
  v_mov_b64 v[224:225], 0
  v_mov_b64 v[226:227], 0
  v_mov_b64 v[228:229], 0
  v_mov_b64 v[230:231], 0
  v_mov_b64 v[232:233], 0
  v_mov_b64 v[234:235], 0
  s_setpc_b64 s[98:99]
F_hsetup2:
  s_sub_u32 s5, s9, 4
  s_mul_i32 s3, s8, 160
  s_lshl_b32 s4, s5, 6

  v_add_u32 v4, s4, v1
  v_add_u32 v4, 0, v4
  v_mul_u32_u24 v5, 6554, v4
  v_lshrrev_b32 v5, 16, v5
  v_mul_u32_u24 v5, 1120, v5
  v_lshl_add_u32 v5, v4, 4, v5
  v_add_u32 v244, s3, v5

  v_add_u32 v4, s4, v1
  v_add_u32 v4, 256, v4
  v_mul_u32_u24 v5, 6554, v4
  v_lshrrev_b32 v5, 16, v5
  v_mul_u32_u24 v5, 1120, v5
  v_lshl_add_u32 v5, v4, 4, v5
  v_add_u32 v245, s3, v5

  v_add_u32 v4, s4, v1
  v_add_u32 v4, 512, v4
  v_mul_u32_u24 v5, 6554, v4
  v_lshrrev_b32 v5, 16, v5
  v_mul_u32_u24 v5, 1120, v5
  v_lshl_add_u32 v5, v4, 4, v5
  v_add_u32 v246, s3, v5

  v_add_u32 v4, s4, v1
  v_add_u32 v4, 768, v4
  v_mul_u32_u24 v5, 6554, v4
  v_lshrrev_b32 v5, 16, v5
  v_mul_u32_u24 v5, 1120, v5
  v_lshl_add_u32 v5, v4, 4, v5
  v_add_u32 v247, s3, v5

  v_add_u32 v4, s4, v1
  v_add_u32 v4, 1024, v4
  v_mul_u32_u24 v5, 6554, v4
  v_lshrrev_b32 v5, 16, v5
  v_mul_u32_u24 v5, 1120, v5
  v_lshl_add_u32 v5, v4, 4, v5
  v_add_u32 v248, s3, v5

  s_lshl_b32 s100, s8, 2
  s_add_u32 s100, s100, s5
  s_mul_i32 s3, s100, 5
  s_lshr_b32 s4, s3, 2
  s_lshl_b32 s4, s4, 10
  s_and_b32 s3, s3, 3
  v_lshl_add_u32 v5, v11, 9, s4
  v_lshl_add_u32 v148, v10, 4, v5
  v_and_b32 v4, 1, v11
  v_lshl_add_u32 v4, v2, 2, v4
  v_subrev_u32 v4, s3, v4
  v_cmp_gt_u32 vcc, 5, v4
  v_add_u32 v4, 2, v4
  v_cmp_gt_u32 s[4:5], 5, v4
  v_cndmask_b32 v149, 0, -1, vcc
  s_nop 0
  v_cndmask_b32 v155, 0, -1, s[4:5]
  s_mul_i32 s3, s100, 20
  v_and_b32 v8, 1, v11
  v_lshlrev_b32 v8, 9, v8
  v_lshl_add_u32 v8, v2, 3, v8

  v_add_u32 v5, s3, v10
  v_add_u32 v5, 0, v5
  v_min_u32 v5, 639, v5
  v_lshrrev_b32 v6, 5, v5
  v_lshlrev_b32 v6, 17, v6
  v_and_b32 v5, 31, v5
  v_lshl_add_u32 v6, v5, 4, v6
  v_add_u32 v150, v6, v8

  v_add_u32 v5, s3, v10
  v_add_u32 v5, 16, v5
  v_min_u32 v5, 639, v5
  v_lshrrev_b32 v6, 5, v5
  v_lshlrev_b32 v6, 17, v6
  v_and_b32 v5, 31, v5
  v_lshl_add_u32 v6, v5, 4, v6
  v_add_u32 v151, v6, v8

  v_cmp_gt_u32 vcc, 4, v10
  v_mov_b32 v5, 0x7fffff00
  s_nop 0
  v_cndmask_b32 v151, v5, v151, vcc

  v_lshlrev_b32 v152, 2, v10
  v_lshlrev_b32 v5, 2, v11
  v_sub_u32 v5, v10, v5
  v_mov_b32 v7, 0xff800000
  s_cmp_eq_u32 s7, 0
  s_cselect_b64 s[4:5], 0, -1

  v_add_u32 v6, 0, v5
  v_and_b32 v6, 0xfffffff1, v6
  v_cmp_eq_u32 vcc, 0, v6
  v_mov_b32 v168, 0x3f803f80
  s_nop 0
  v_cndmask_b32 v156, v7, 0, vcc

  v_add_u32 v6, -1, v5
  v_and_b32 v6, 0xfffffff1, v6
  v_cmp_eq_u32 vcc, 0, v6
  v_mov_b32 v169, 0x3f803f80
  s_nop 0
  v_cndmask_b32 v157, v7, 0, vcc

  v_add_u32 v6, -2, v5
  v_and_b32 v6, 0xfffffff1, v6
  v_cmp_eq_u32 vcc, 0, v6
  v_mov_b32 v170, 0x3f803f80
  s_nop 0
  v_cndmask_b32 v158, v7, 0, vcc

  v_add_u32 v6, -3, v5
  v_and_b32 v6, 0xfffffff1, v6
  v_cmp_eq_u32 vcc, 0, v6
  v_mov_b32 v171, 0x3f803f80
  s_nop 0
  v_cndmask_b32 v159, v7, 0, vcc

  v_add_u32 v6, 16, v5
  v_and_b32 v6, 0xfffffff1, v6
  v_cmp_eq_u32 vcc, 0, v6
  v_mov_b32 v168, 0x3f803f80
  s_nop 0
  v_cndmask_b32 v160, v7, 0, vcc

  v_cndmask_b32 v164, v7, v160, s[4:5]
  v_add_u32 v6, 15, v5
  v_and_b32 v6, 0xfffffff1, v6
  v_cmp_eq_u32 vcc, 0, v6
  v_mov_b32 v169, 0x3f803f80
  s_nop 0
  v_cndmask_b32 v161, v7, 0, vcc

  v_cndmask_b32 v165, v7, v161, s[4:5]
  v_add_u32 v6, 14, v5
  v_and_b32 v6, 0xfffffff1, v6
  v_cmp_eq_u32 vcc, 0, v6
  v_mov_b32 v170, 0x3f803f80
  s_nop 0
  v_cndmask_b32 v162, v7, 0, vcc

  v_cndmask_b32 v166, v7, v162, s[4:5]
  v_add_u32 v6, 13, v5
  v_and_b32 v6, 0xfffffff1, v6
  v_cmp_eq_u32 vcc, 0, v6
  v_mov_b32 v171, 0x3f803f80
  s_nop 0
  v_cndmask_b32 v163, v7, 0, vcc

  v_cndmask_b32 v167, v7, v163, s[4:5]
  s_mov_b32 s100, 0
F_gsetup:
  v_and_b32 v4, 1, v11
  v_lshrrev_b32 v6, 2, v10
  v_mul_u32_u24 v6, 160, v6
  v_and_b32 v7, 3, v10
  v_lshl_add_u32 v6, v7, 3, v6
  v_add_u32 v6, s100, v6
  v_mul_u32_u24 v7, 640, v4
  v_add_u32 v7, v7, v6
  v_mul_u32_u24 v4, 6400, v4
  v_add_u32 v4, v4, v6
  v_mul_u32_u24 v5, 3200, v2
  v_add_u32 v249, v5, v7
  v_cmp_eq_u32 vcc, 1, v2

  v_add_u32 v5, 2560, v4
  v_add_u32 v6, 12800, v7
  v_cndmask_b32 v250, v5, v6, vcc
  v_add_u32 v5, 22400, v7
  v_add_u32 v6, 15360, v4
  v_cndmask_b32 v252, v5, v6, vcc

  v_add_u32 v5, 5760, v4
  v_add_u32 v6, 14080, v7
  v_cndmask_b32 v251, v5, v6, vcc
  v_add_u32 v5, 23680, v7
  v_add_u32 v6, 18560, v4
  v_cndmask_b32 v253, v5, v6, vcc

  s_and_b32 s3, s9, 1
  s_lshl_b32 s3, s3, 8
  v_lshlrev_b32 v254, 4, v10
  v_lshl_add_u32 v254, v11, 9, v254
  v_add_u32 v254, s3, v254
  s_bfe_u32 s3, s9, 0x10001
  s_lshl_b32 s4, s7, 1
  s_add_u32 s3, s3, s4
  s_mul_i32 s21, s3, 81920
  s_add_u32 s21, s21, 8257536
  s_setpc_b64 s[98:99]

F_wpre:
  ds_read_b64_tr_b16 v[84:85], v249 offset:0
  ds_read_b64_tr_b16 v[86:87], v249 offset:1280
  ds_read_b64_tr_b16 v[88:89], v249 offset:32
  ds_read_b64_tr_b16 v[90:91], v249 offset:1312
  ds_read_b64_tr_b16 v[92:93], v249 offset:64
  ds_read_b64_tr_b16 v[94:95], v249 offset:1344
  ds_read_b64_tr_b16 v[96:97], v249 offset:96
  ds_read_b64_tr_b16 v[98:99], v249 offset:1376
  ds_read_b64_tr_b16 v[100:101], v249 offset:128
  ds_read_b64_tr_b16 v[102:103], v249 offset:1408
  ds_read_b64_tr_b16 v[104:105], v249 offset:6400
  ds_read_b64_tr_b16 v[106:107], v249 offset:7680
  ds_read_b64_tr_b16 v[108:109], v249 offset:6432
  ds_read_b64_tr_b16 v[110:111], v249 offset:7712
  ds_read_b64_tr_b16 v[112:113], v249 offset:6464
  ds_read_b64_tr_b16 v[114:115], v249 offset:7744
  ds_read_b64_tr_b16 v[116:117], v249 offset:6496
  ds_read_b64_tr_b16 v[118:119], v249 offset:7776
  ds_read_b64_tr_b16 v[120:121], v249 offset:6528
  ds_read_b64_tr_b16 v[122:123], v249 offset:7808
  ds_read_b64_tr_b16 v[124:125], v250 offset:0
  ds_read_b64_tr_b16 v[126:127], v251 offset:0
  ds_read_b64_tr_b16 v[128:129], v250 offset:32
  ds_read_b64_tr_b16 v[130:131], v251 offset:32
  ds_read_b64_tr_b16 v[132:133], v250 offset:64
  ds_read_b64_tr_b16 v[134:135], v251 offset:64
  ds_read_b64_tr_b16 v[136:137], v250 offset:96
  ds_read_b64_tr_b16 v[138:139], v251 offset:96
  ds_read_b64_tr_b16 v[140:141], v250 offset:128
  ds_read_b64_tr_b16 v[142:143], v251 offset:128
  ds_read_b64_tr_b16 v[144:145], v249 offset:16000
  ds_read_b64_tr_b16 v[146:147], v249 offset:17280
  ds_read_b64_tr_b16 v[148:149], v249 offset:16032
  ds_read_b64_tr_b16 v[150:151], v249 offset:17312
  ds_read_b64_tr_b16 v[152:153], v249 offset:16064
  ds_read_b64_tr_b16 v[154:155], v249 offset:17344
  ds_read_b64_tr_b16 v[156:157], v249 offset:16096
  ds_read_b64_tr_b16 v[158:159], v249 offset:17376
  ds_read_b64_tr_b16 v[160:161], v249 offset:16128
  ds_read_b64_tr_b16 v[162:163], v249 offset:17408
  ds_read_b64_tr_b16 v[164:165], v252 offset:0
  ds_read_b64_tr_b16 v[166:167], v253 offset:0
  ds_read_b64_tr_b16 v[168:169], v252 offset:32
  ds_read_b64_tr_b16 v[170:171], v253 offset:32
  ds_read_b64_tr_b16 v[172:173], v252 offset:64
  ds_read_b64_tr_b16 v[174:175], v253 offset:64
  ds_read_b64_tr_b16 v[176:177], v252 offset:96
  ds_read_b64_tr_b16 v[178:179], v253 offset:96
  ds_read_b64_tr_b16 v[180:181], v252 offset:128
  ds_read_b64_tr_b16 v[182:183], v253 offset:128
  ds_read_b64_tr_b16 v[184:185], v249 offset:25600
  ds_read_b64_tr_b16 v[186:187], v249 offset:26880
  ds_read_b64_tr_b16 v[188:189], v249 offset:25632
  ds_read_b64_tr_b16 v[190:191], v249 offset:26912
  ds_read_b64_tr_b16 v[192:193], v249 offset:25664
  ds_read_b64_tr_b16 v[194:195], v249 offset:26944
  ds_read_b64_tr_b16 v[196:197], v249 offset:25696
  ds_read_b64_tr_b16 v[198:199], v249 offset:26976
  ds_read_b64_tr_b16 v[200:201], v249 offset:25728
  ds_read_b64_tr_b16 v[202:203], v249 offset:27008
  ds_read_b64_tr_b16 v[204:205], v249 offset:32000
  ds_read_b64_tr_b16 v[206:207], v249 offset:33280
  ds_read_b64_tr_b16 v[208:209], v249 offset:32032
  ds_read_b64_tr_b16 v[210:211], v249 offset:33312
  ds_read_b64_tr_b16 v[212:213], v249 offset:32064
  ds_read_b64_tr_b16 v[214:215], v249 offset:33344
  ds_read_b64_tr_b16 v[216:217], v249 offset:32096
  ds_read_b64_tr_b16 v[218:219], v249 offset:33376
  ds_read_b64_tr_b16 v[220:221], v249 offset:32128
  ds_read_b64_tr_b16 v[222:223], v249 offset:33408
  ds_read_b64_tr_b16 v[224:225], v250 offset:25600
  ds_read_b64_tr_b16 v[226:227], v251 offset:25600
  ds_read_b64_tr_b16 v[228:229], v250 offset:25632
  ds_read_b64_tr_b16 v[230:231], v251 offset:25632
  ds_read_b64_tr_b16 v[232:233], v250 offset:25664
  ds_read_b64_tr_b16 v[234:235], v251 offset:25664
  ds_read_b64_tr_b16 v[236:237], v250 offset:25696
  ds_read_b64_tr_b16 v[238:239], v251 offset:25696
  ds_read_b64_tr_b16 v[240:241], v250 offset:25728
  ds_read_b64_tr_b16 v[242:243], v251 offset:25728
  s_setpc_b64 s[98:99]
F_wpf:
  v_lshlrev_b32 v92, 4, v1
  s_mov_b32 exec_hi, 0xff

  buffer_load_dwordx4 v[96:99], v92, s[52:55], s15 offen offset:0
  buffer_load_dwordx4 v[96:99], v92, s[52:55], s15 offen offset:1280
  buffer_load_dwordx4 v[96:99], v92, s[52:55], s15 offen offset:2560
  s_add_u32 s15, s15, 3840
  buffer_load_dwordx4 v[96:99], v92, s[52:55], s15 offen offset:0
  buffer_load_dwordx4 v[96:99], v92, s[52:55], s15 offen offset:1280
  buffer_load_dwordx4 v[96:99], v92, s[52:55], s15 offen offset:2560
  s_add_u32 s15, s15, 3840
  buffer_load_dwordx4 v[96:99], v92, s[52:55], s15 offen offset:0
  buffer_load_dwordx4 v[96:99], v92, s[52:55], s15 offen offset:1280
  buffer_load_dwordx4 v[96:99], v92, s[52:55], s15 offen offset:2560
  s_add_u32 s15, s15, 3840
  buffer_load_dwordx4 v[96:99], v92, s[52:55], s15 offen offset:0
  s_mov_b32 exec_hi, -1
  s_setpc_b64 s[98:99]

F_wob:
  s_cmp_ge_u32 s15, s14
  s_cbranch_scc1 F_wob9
  s_setprio 0
  s_cmp_ge_u32 s15, 5
  s_cbranch_scc1 F_wobA
  s_add_u32 s3, s15, s13
  s_cmp_ge_u32 s3, 5
  s_cselect_b32 s4, 5, 0
  s_sub_u32 s3, s3, s4
  s_mul_i32 s4, s3, 163840
  s_mul_i32 s5, s3, 20480
  s_add_u32 s5, s5, 0
  s_mov_b32 s3, 0
  s_branch F_wob1

F_wobA:
  s_mov_b32 s44, s24
  s_mov_b32 s45, s25
  s_add_u32 s3, s15, s13
  s_mul_i32 s4, s3, 86
  s_lshr_b32 s4, s4, 8
  s_mul_i32 s4, s4, 3
  s_sub_u32 s3, s3, s4
  s_mul_i32 s4, s3, 163840
  s_mul_i32 s5, s3, 20480
  s_cmp_ge_u32 s15, 8
  s_cselect_b32 s20, 1, 0

  s_and_b32 s20, s20, 1
  s_mul_i32 s20, s20, 409600
  s_add_u32 s4, s4, s20
  s_cmp_ge_u32 s15, 8
  s_cselect_b32 s20, 0, 102400
  s_add_u32 s5, s5, s20
  s_lshr_b32 s3, s3, 1
  s_lshr_b32 s20, s10, 1
  s_mul_i32 s20, s20, s3
  s_add_u32 s3, s3, s20

F_wob1:
  s_add_u32 s5, s5, s12
  s_add_u32 s15, s15, 1
  s_add_u32 m0, s5, 0
  s_waitcnt vmcnt(3)
  buffer_load_dwordx4 v244, s[44:47], s4 offen lds
  s_add_u32 m0, s5, 4096
  s_waitcnt vmcnt(3)
  buffer_load_dwordx4 v245, s[44:47], s4 offen lds
  s_cmp_eq_u32 s3, 2
  s_cbranch_scc1 F_wob8
  s_add_u32 m0, s5, 8192
  s_waitcnt vmcnt(3)
  buffer_load_dwordx4 v246, s[44:47], s4 offen lds
  s_cmp_eq_u32 s3, 1
  s_cbranch_scc1 F_wob8
  s_add_u32 m0, s5, 12288
  s_waitcnt vmcnt(3)
  buffer_load_dwordx4 v247, s[44:47], s4 offen lds
  s_add_u32 m0, s5, 16384
  s_waitcnt vmcnt(3)
  buffer_load_dwordx4 v248, s[44:47], s4 offen lds
F_wob8:
  s_setprio 1
F_wob9:
  s_setpc_b64 s[98:99]
F_extra:
  v_bfe_u32 v4, v1, 2, 2
  v_lshl_add_u32 v106, v2, 3, v4
  v_and_b32 v5, 3, v1
  v_bfe_u32 v6, v1, 4, 1
  v_lshl_add_u32 v5, v6, 2, v5
  v_min_u32 v5, 4, v5
  v_lshlrev_b32 v107, 3, v5
  v_mov_b32 v22, 161792
  v_mov_b32 v23, 1

  v_mov_b64 v[24:25], 0
  v_mov_b64 v[26:27], 0
  v_mov_b64 v[28:29], 0
  v_mov_b64 v[30:31], 0
  v_mov_b64 v[32:33], 0
  v_mov_b64 v[34:35], 0
  v_mov_b64 v[36:37], 0
  v_mov_b64 v[38:39], 0
  s_waitcnt lgkmcnt(0)
  s_mov_b32 s48, s38
  s_mov_b32 s49, s39
  s_mov_b32 s50, 14024704
  s_mov_b32 s51, 0x20000
  s_mov_b32 s5, 0
  s_mov_b32 s10, 0

  ds_read_b64 v[104:105], v22
  v_mul_u32_u24 v4, 40, v106
  v_add_u32 v20, v4, v107
  v_add_u32 v20, 122880, v20
  s_mov_b32 s12, 5120
  s_setprio 3
  s_sub_u32 s11, s9, 4
  s_and_b32 s3, s96, 1
  s_add_u32 s11, s11, s3
  s_lshl_b32 s15, s11, 12
  s_lshl_b32 s3, s7, 1
  s_add_u32 s3, s3, s11
  s_mul_i32 s3, s3, 2816
  s_add_u32 s13, s3, 7864320
  s_cmp_eq_u32 s96, 4
  s_cbranch_scc1 F_exG
  s_cmp_ge_u32 s96, 2
  s_cbranch_scc1 F_exV

  s_lshl_b32 s3, s60, 14
  s_add_u32 s3, s3, s15
  s_mul_i32 s4, s60, s12
  s_add_u32 s60, s60, 1
  s_cmp_eq_u32 s60, 5
  s_cselect_b32 s60, 0, s60
  s_add_u32 s10, s10, 1
  s_cmp_eq_u32 s10, 6
  s_cselect_b32 s10, 0, s10

  v_add_u32 v16, s3, v12
  v_add_u32 v17, s3, v13
  v_add_u32 v18, s3, v14
  v_add_u32 v19, s3, v15
  v_add_u32 v21, s4, v20
  s_waitcnt lgkmcnt(0)
F_l7w0:
  v_readfirstlane_b32 s3, v104
  v_readfirstlane_b32 s4, v105
  s_min_u32 s3, s3, s4
  s_cmp_ge_u32 s3, s10
  s_cbranch_scc1 F_l7w0_go

  ds_read_b64 v[104:105], v22 offset:0
  s_add_u32 s5, s5, 1
  s_cmp_lt_u32 s5, 1600000
  s_waitcnt lgkmcnt(0)
  s_cbranch_scc1 F_l7w0

F_l7w0_go:
  ds_read_b128 v[40:43], v16 offset:0
  ds_read_b64_tr_b16 v[72:73], v21 offset:0
  ds_read_b64_tr_b16 v[74:75], v21 offset:160
  ds_read_b128 v[44:47], v17 offset:0
  ds_read_b64_tr_b16 v[76:77], v21 offset:640
  ds_read_b64_tr_b16 v[78:79], v21 offset:800
  ds_read_b128 v[48:51], v18 offset:0
  ds_read_b64_tr_b16 v[80:81], v21 offset:1280
  ds_read_b64_tr_b16 v[82:83], v21 offset:1440
  ds_read_b128 v[52:55], v19 offset:0
  ds_read_b64_tr_b16 v[84:85], v21 offset:1920
  ds_read_b64_tr_b16 v[86:87], v21 offset:2080
F_l7:
  ds_read_b128 v[56:59], v16 offset:8192
  ds_read_b64_tr_b16 v[88:89], v21 offset:2560
  ds_read_b64_tr_b16 v[90:91], v21 offset:2720
  s_waitcnt lgkmcnt(12)
  v_mfma_f32_32x32x16_bf16 v[24:39], v[72:75], v[40:43], v[24:39]
  ds_read_b128 v[60:63], v17 offset:8192
  ds_read_b64_tr_b16 v[92:93], v21 offset:3200
  ds_read_b64_tr_b16 v[94:95], v21 offset:3360
  ds_read_b64 v[104:105], v22
  s_waitcnt lgkmcnt(13)
  v_mfma_f32_32x32x16_bf16 v[24:39], v[76:79], v[44:47], v[24:39]
  ds_read_b128 v[64:67], v18 offset:8192
  ds_read_b64_tr_b16 v[96:97], v21 offset:3840
  ds_read_b64_tr_b16 v[98:99], v21 offset:4000
  s_waitcnt lgkmcnt(13)
  v_mfma_f32_32x32x16_bf16 v[24:39], v[80:83], v[48:51], v[24:39]
  ds_read_b128 v[68:71], v19 offset:8192
  ds_read_b64_tr_b16 v[100:101], v21 offset:4480
  ds_read_b64_tr_b16 v[102:103], v21 offset:4640
  s_waitcnt lgkmcnt(13)
  v_mfma_f32_32x32x16_bf16 v[24:39], v[84:87], v[52:55], v[24:39]
  s_lshl_b32 s3, s60, 14
  s_add_u32 s3, s3, s15
  s_mul_i32 s4, s60, s12
  s_add_u32 s60, s60, 1
  s_cmp_eq_u32 s60, 5
  s_cselect_b32 s60, 0, s60
  s_add_u32 s10, s10, 1
  s_cmp_eq_u32 s10, 6
  s_cselect_b32 s10, 0, s10

  v_add_u32 v16, s3, v12
  v_add_u32 v17, s3, v13
  v_add_u32 v18, s3, v14
  v_add_u32 v19, s3, v15
  v_add_u32 v21, s4, v20
  s_waitcnt lgkmcnt(6)
F_l7w:
  v_readfirstlane_b32 s3, v104
  v_readfirstlane_b32 s4, v105
  s_min_u32 s3, s3, s4
  s_cmp_ge_u32 s3, s10
  s_cbranch_scc1 F_l7w_go

  ds_read_b64 v[104:105], v22 offset:0
  s_add_u32 s5, s5, 1
  s_cmp_lt_u32 s5, 1600000
  s_waitcnt lgkmcnt(0)
  s_cbranch_scc1 F_l7w

F_l7w_go:
  ds_read_b128 v[40:43], v16 offset:0
  ds_read_b64_tr_b16 v[72:73], v21 offset:0
  ds_read_b64_tr_b16 v[74:75], v21 offset:160
  v_mfma_f32_32x32x16_bf16 v[24:39], v[88:91], v[56:59], v[24:39]
  ds_read_b128 v[44:47], v17 offset:0
  ds_read_b64_tr_b16 v[76:77], v21 offset:640
  ds_read_b64_tr_b16 v[78:79], v21 offset:800
  v_mfma_f32_32x32x16_bf16 v[24:39], v[92:95], v[60:63], v[24:39]
  ds_read_b128 v[48:51], v18 offset:0
  ds_read_b64_tr_b16 v[80:81], v21 offset:1280
  ds_read_b64_tr_b16 v[82:83], v21 offset:1440
  s_waitcnt lgkmcnt(12)
  v_mfma_f32_32x32x16_bf16 v[24:39], v[96:99], v[64:67], v[24:39]
  ds_read_b128 v[52:55], v19 offset:0
  ds_read_b64_tr_b16 v[84:85], v21 offset:1920
  ds_read_b64_tr_b16 v[86:87], v21 offset:2080
  s_waitcnt lgkmcnt(12)
  v_mfma_f32_32x32x16_bf16 v[24:39], v[100:103], v[68:71], v[24:39]
  s_cmp_lg_u32 s10, 0
  s_cbranch_scc1 F_l7
  s_waitcnt lgkmcnt(0)
  s_mov_b64 exec, 1
  ds_add_u32 v22, v23 offset:56
  s_mov_b64 exec, -1
  s_nop 7
  s_nop 3

  v_lshlrev_b32 v4, 4, v1
  v_lshlrev_b32 v5, 3, v1

  v_cvt_pk_bf16_f32 v24, v24, v25
  v_cvt_pk_bf16_f32 v25, v26, v27
  v_cvt_pk_bf16_f32 v26, v28, v29
  v_cvt_pk_bf16_f32 v27, v30, v31
  v_cvt_pk_bf16_f32 v28, v32, v33
  v_cvt_pk_bf16_f32 v29, v34, v35
  s_mov_b32 exec_lo, 0
  v_mov_b32 v28, 0x3f803f80
  v_mov_b32 v29, 0x3f80
  s_mov_b32 exec_lo, -1
  buffer_store_dwordx4 v[24:27], v4, s[48:51], s13 offen sc1
  s_mov_b32 exec_hi, 1
  buffer_store_dwordx2 v[28:29], v5, s[48:51], s13 offen offset:1024 sc1
  s_mov_b32 exec_hi, -1

F_exflag:
  v_mov_b32 v8, 161792
  s_mov_b32 s4, 0
F_l8:
  ds_read_b64 v[6:7], v8 offset:40
  s_add_u32 s4, s4, 1
  s_waitcnt lgkmcnt(0)
  v_readfirstlane_b32 s62, v6
  v_readfirstlane_b32 s63, v7
  s_cmp_lg_u32 s62, 0
  s_cbranch_scc1 F_l8_ok
  s_cmp_lt_u32 s4, 1600000
  s_cbranch_scc1 F_l8

F_l8_ok:
  s_lshl_b32 s3, s7, 1
  s_lshr_b32 s4, s96, 1
  s_add_u32 s3, s3, s4
  s_lshl_b32 s3, s3, 7
  s_lshl_b32 s4, s11, 3
  s_add_u32 s3, s3, s4
  s_add_u32 s3, s3, 8052736
  v_mov_b32 v4, 0
  s_waitcnt vmcnt(0)
  s_mov_b64 exec, 1
  buffer_store_dwordx2 v[6:7], v4, s[48:51], s3 offen sc1
  s_mov_b64 exec, -1

  s_branch F_hpre2
F_exV:
  s_lshl_b32 s3, s60, 14
  s_add_u32 s3, s3, s15
  s_mul_i32 s4, s60, s12
  s_add_u32 s60, s60, 1
  s_cmp_eq_u32 s60, 5
  s_cselect_b32 s60, 0, s60
  s_add_u32 s10, s10, 1
  s_cmp_eq_u32 s10, 6
  s_cselect_b32 s10, 0, s10

  v_add_u32 v16, s3, v12
  v_add_u32 v17, s3, v13
  v_add_u32 v18, s3, v14
  v_add_u32 v19, s3, v15
  v_add_u32 v21, s4, v20
  s_waitcnt lgkmcnt(0)
F_l9w0:
  v_readfirstlane_b32 s3, v104
  v_readfirstlane_b32 s4, v105
  s_min_u32 s3, s3, s4
  s_cmp_ge_u32 s3, s10
  s_cbranch_scc1 F_l9w0_go

  ds_read_b64 v[104:105], v22 offset:0
  s_add_u32 s5, s5, 1
  s_cmp_lt_u32 s5, 1600000
  s_waitcnt lgkmcnt(0)
  s_cbranch_scc1 F_l9w0

F_l9w0_go:
  ds_read_b128 v[40:43], v16 offset:0
  ds_read_b64_tr_b16 v[72:73], v21 offset:0
  ds_read_b64_tr_b16 v[74:75], v21 offset:160
  ds_read_b128 v[44:47], v17 offset:0
  ds_read_b64_tr_b16 v[76:77], v21 offset:640
  ds_read_b64_tr_b16 v[78:79], v21 offset:800
  ds_read_b128 v[48:51], v18 offset:0
  ds_read_b64_tr_b16 v[80:81], v21 offset:1280
  ds_read_b64_tr_b16 v[82:83], v21 offset:1440
  ds_read_b128 v[52:55], v19 offset:0
  ds_read_b64_tr_b16 v[84:85], v21 offset:1920
  ds_read_b64_tr_b16 v[86:87], v21 offset:2080
F_l9:
  ds_read_b128 v[56:59], v16 offset:8192
  ds_read_b64_tr_b16 v[88:89], v21 offset:2560
  ds_read_b64_tr_b16 v[90:91], v21 offset:2720
  s_waitcnt lgkmcnt(12)
  v_mfma_f32_32x32x16_bf16 v[24:39], v[40:43], v[72:75], v[24:39]
  ds_read_b128 v[60:63], v17 offset:8192
  ds_read_b64_tr_b16 v[92:93], v21 offset:3200
  ds_read_b64_tr_b16 v[94:95], v21 offset:3360
  ds_read_b64 v[104:105], v22
  s_waitcnt lgkmcnt(13)
  v_mfma_f32_32x32x16_bf16 v[24:39], v[44:47], v[76:79], v[24:39]
  ds_read_b128 v[64:67], v18 offset:8192
  ds_read_b64_tr_b16 v[96:97], v21 offset:3840
  ds_read_b64_tr_b16 v[98:99], v21 offset:4000
  s_waitcnt lgkmcnt(13)
  v_mfma_f32_32x32x16_bf16 v[24:39], v[48:51], v[80:83], v[24:39]
  ds_read_b128 v[68:71], v19 offset:8192
  ds_read_b64_tr_b16 v[100:101], v21 offset:4480
  ds_read_b64_tr_b16 v[102:103], v21 offset:4640
  s_waitcnt lgkmcnt(13)
  v_mfma_f32_32x32x16_bf16 v[24:39], v[52:55], v[84:87], v[24:39]
  s_lshl_b32 s3, s60, 14
  s_add_u32 s3, s3, s15
  s_mul_i32 s4, s60, s12
  s_add_u32 s60, s60, 1
  s_cmp_eq_u32 s60, 5
  s_cselect_b32 s60, 0, s60
  s_add_u32 s10, s10, 1
  s_cmp_eq_u32 s10, 6
  s_cselect_b32 s10, 0, s10

  v_add_u32 v16, s3, v12
  v_add_u32 v17, s3, v13
  v_add_u32 v18, s3, v14
  v_add_u32 v19, s3, v15
  v_add_u32 v21, s4, v20
  s_waitcnt lgkmcnt(6)
F_l9w:
  v_readfirstlane_b32 s3, v104
  v_readfirstlane_b32 s4, v105
  s_min_u32 s3, s3, s4
  s_cmp_ge_u32 s3, s10
  s_cbranch_scc1 F_l9w_go

  ds_read_b64 v[104:105], v22 offset:0
  s_add_u32 s5, s5, 1
  s_cmp_lt_u32 s5, 1600000
  s_waitcnt lgkmcnt(0)
  s_cbranch_scc1 F_l9w

F_l9w_go:
  ds_read_b128 v[40:43], v16 offset:0
  ds_read_b64_tr_b16 v[72:73], v21 offset:0
  ds_read_b64_tr_b16 v[74:75], v21 offset:160
  v_mfma_f32_32x32x16_bf16 v[24:39], v[56:59], v[88:91], v[24:39]
  ds_read_b128 v[44:47], v17 offset:0
  ds_read_b64_tr_b16 v[76:77], v21 offset:640
  ds_read_b64_tr_b16 v[78:79], v21 offset:800
  v_mfma_f32_32x32x16_bf16 v[24:39], v[60:63], v[92:95], v[24:39]
  ds_read_b128 v[48:51], v18 offset:0
  ds_read_b64_tr_b16 v[80:81], v21 offset:1280
  ds_read_b64_tr_b16 v[82:83], v21 offset:1440
  s_waitcnt lgkmcnt(12)
  v_mfma_f32_32x32x16_bf16 v[24:39], v[64:67], v[96:99], v[24:39]
  ds_read_b128 v[52:55], v19 offset:0
  ds_read_b64_tr_b16 v[84:85], v21 offset:1920
  ds_read_b64_tr_b16 v[86:87], v21 offset:2080
  s_waitcnt lgkmcnt(12)
  v_mfma_f32_32x32x16_bf16 v[24:39], v[68:71], v[100:103], v[24:39]
  s_cmp_lg_u32 s10, 0
  s_cbranch_scc1 F_l9
  s_waitcnt lgkmcnt(0)
  s_mov_b64 exec, 1
  ds_add_u32 v22, v23 offset:56
  s_mov_b64 exec, -1
  s_nop 7
  s_nop 3

  v_mul_u32_u24 v4, 336, v2
  v_lshl_add_u32 v4, v3, 4, v4
  v_mov_b32 v5, 0x3f803f80
  v_cmp_eq_u32 vcc, 20, v3
  s_mov_b32 s4, 0x1fffff
  s_mov_b32 s5, 0x1fffff

  v_cvt_pk_bf16_f32 v24, v24, v25
  v_cvt_pk_bf16_f32 v25, v26, v27
  v_cvt_pk_bf16_f32 v26, v28, v29
  v_cvt_pk_bf16_f32 v27, v30, v31
  v_cvt_pk_bf16_f32 v28, v32, v33
  v_cvt_pk_bf16_f32 v29, v34, v35
  v_cvt_pk_bf16_f32 v30, v36, v37
  v_cvt_pk_bf16_f32 v31, v38, v39
  v_cndmask_b32 v24, v24, v5, vcc
  v_cndmask_b32 v25, v25, v5, vcc
  v_cndmask_b32 v26, v26, v5, vcc
  v_cndmask_b32 v27, v27, v5, vcc
  v_cndmask_b32 v28, v28, v5, vcc
  v_cndmask_b32 v29, v29, v5, vcc
  v_cndmask_b32 v30, v30, v5, vcc
  v_cndmask_b32 v31, v31, v5, vcc
  s_mov_b64 exec, s[4:5]
  buffer_store_dwordx4 v[24:27], v4, s[48:51], s13 offen offset:1408 sc1
  buffer_store_dwordx4 v[28:31], v4, s[48:51], s13 offen offset:2080 sc1
  s_mov_b64 exec, -1

  s_branch F_exflag
F_exG:
  v_lshlrev_b32 v20, 4, v2
  v_add_u32 v20, 162048, v20
  s_setprio 0
  s_mov_b32 s12, 256

  s_lshl_b32 s3, s60, 14
  s_add_u32 s3, s3, s15
  s_mul_i32 s4, s60, s12
  s_add_u32 s60, s60, 1
  s_cmp_eq_u32 s60, 5
  s_cselect_b32 s60, 0, s60
  s_add_u32 s10, s10, 1
  s_cmp_eq_u32 s10, 6
  s_cselect_b32 s10, 0, s10

  v_add_u32 v16, s3, v12
  v_add_u32 v17, s3, v13
  v_add_u32 v18, s3, v14
  v_add_u32 v19, s3, v15
  v_add_u32 v21, s4, v20
  s_waitcnt lgkmcnt(0)
F_l10w0:
  v_readfirstlane_b32 s3, v104
  v_readfirstlane_b32 s4, v105
  s_min_u32 s3, s3, s4
  s_cmp_ge_u32 s3, 10
  s_cbranch_scc1 F_l10w0_go

  ds_read_b64 v[104:105], v22 offset:0
  s_add_u32 s5, s5, 1
  s_cmp_lt_u32 s5, 1600000
  s_waitcnt lgkmcnt(0)
  s_cbranch_scc1 F_l10w0

F_l10w0_go:
  ds_read_b128 v[40:43], v16 offset:0
  ds_read_b128 v[72:75], v21 offset:0
  ds_read_b128 v[44:47], v17 offset:0
  ds_read_b128 v[76:79], v21 offset:32
  ds_read_b128 v[48:51], v18 offset:0
  ds_read_b128 v[80:83], v21 offset:64
  ds_read_b128 v[52:55], v19 offset:0
  ds_read_b128 v[84:87], v21 offset:96
F_l10:
  ds_read_b128 v[56:59], v16 offset:8192
  ds_read_b128 v[88:91], v21 offset:128
  s_waitcnt lgkmcnt(8)
  v_mfma_f32_32x32x16_bf16 v[24:39], v[72:75], v[40:43], v[24:39]
  ds_read_b128 v[60:63], v17 offset:8192
  ds_read_b128 v[92:95], v21 offset:160
  ds_read_b64 v[104:105], v22
  s_waitcnt lgkmcnt(9)
  v_mfma_f32_32x32x16_bf16 v[24:39], v[76:79], v[44:47], v[24:39]
  ds_read_b128 v[64:67], v18 offset:8192
  ds_read_b128 v[96:99], v21 offset:192
  s_waitcnt lgkmcnt(9)
  v_mfma_f32_32x32x16_bf16 v[24:39], v[80:83], v[48:51], v[24:39]
  ds_read_b128 v[68:71], v19 offset:8192
  ds_read_b128 v[100:103], v21 offset:224
  s_waitcnt lgkmcnt(9)
  v_mfma_f32_32x32x16_bf16 v[24:39], v[84:87], v[52:55], v[24:39]
  s_lshl_b32 s3, s60, 14
  s_add_u32 s3, s3, s15
  s_mul_i32 s4, s60, s12
  s_add_u32 s60, s60, 1
  s_cmp_eq_u32 s60, 5
  s_cselect_b32 s60, 0, s60
  s_add_u32 s10, s10, 1
  s_cmp_eq_u32 s10, 6
  s_cselect_b32 s10, 0, s10

  v_add_u32 v16, s3, v12
  v_add_u32 v17, s3, v13
  v_add_u32 v18, s3, v14
  v_add_u32 v19, s3, v15
  v_add_u32 v21, s4, v20
  s_waitcnt lgkmcnt(4)
F_l10w:
  v_readfirstlane_b32 s3, v104
  v_readfirstlane_b32 s4, v105
  s_min_u32 s3, s3, s4
  s_cmp_ge_u32 s3, s10
  s_cbranch_scc1 F_l10w_go

  ds_read_b64 v[104:105], v22 offset:0
  s_add_u32 s5, s5, 1
  s_cmp_lt_u32 s5, 1600000
  s_waitcnt lgkmcnt(0)
  s_cbranch_scc1 F_l10w

F_l10w_go:
  ds_read_b128 v[40:43], v16 offset:0
  ds_read_b128 v[72:75], v21 offset:0
  v_mfma_f32_32x32x16_bf16 v[24:39], v[88:91], v[56:59], v[24:39]
  ds_read_b128 v[44:47], v17 offset:0
  ds_read_b128 v[76:79], v21 offset:32
  v_mfma_f32_32x32x16_bf16 v[24:39], v[92:95], v[60:63], v[24:39]
  ds_read_b128 v[48:51], v18 offset:0
  ds_read_b128 v[80:83], v21 offset:64
  s_waitcnt lgkmcnt(8)
  v_mfma_f32_32x32x16_bf16 v[24:39], v[96:99], v[64:67], v[24:39]
  ds_read_b128 v[52:55], v19 offset:0
  ds_read_b128 v[84:87], v21 offset:96
  s_waitcnt lgkmcnt(8)
  v_mfma_f32_32x32x16_bf16 v[24:39], v[100:103], v[68:71], v[24:39]
  s_cmp_lg_u32 s10, 0
  s_cbranch_scc1 F_l10
  s_waitcnt lgkmcnt(0)
  s_mov_b64 exec, 1
  ds_add_u32 v22, v23 offset:56
  s_mov_b64 exec, -1
  s_nop 7
  s_nop 3

  s_lshl_b32 s3, s7, 8
  s_lshl_b32 s4, s11, 7
  s_add_u32 s3, s3, s4
  s_add_u32 s3, s3, 8044544
  v_mul_f32 v4, 0xbfb8aa3b, v24
  v_exp_f32 v4, v4
  v_lshlrev_b32 v5, 2, v3
  v_add_f32 v4, 1.0, v4
  v_rcp_f32 v4, v4
  s_mov_b32 exec_hi, 0
  buffer_store_dword v4, v5, s[48:51], s3 offen sc1
  s_mov_b32 exec_hi, -1

F_hpre2:
  s_setprio 0
  s_call_b64 s[98:99], F_hsetup2
F_hpre:
  s_mov_b32 s48, s38
  s_mov_b32 s49, s39
  s_mov_b32 s50, 14024704
  s_mov_b32 s51, 0x20000
  s_mov_b32 s44, s28
  s_mov_b32 s45, s29
  s_mov_b32 s46, 2457600
  s_mov_b32 s47, 0x20000
  s_sub_u32 s10, s9, 4
  s_lshl_b32 s3, s8, 9
  s_lshl_b32 s4, s10, 7
  s_add_u32 s11, s3, s4
  s_lshl_b32 s12, s10, 13
  s_add_u32 s12, s12, 122880

  s_and_b32 s3, s7, 7
  s_mul_i32 s3, s3, 5
  s_lshr_b32 s13, s3, 2
  s_mul_i32 s14, s13, 245760
  s_lshl_b32 s13, s13, 13
  s_mov_b32 s19, 0
  s_cmp_ge_u32 s11, 3840
  s_cselect_b32 s46, 0, s46

  v_add_u32 v16, s13, v12
  v_add_u32 v17, s13, v13
  v_add_u32 v18, s13, v14
  v_add_u32 v19, s13, v15
  v_mov_b32 v5, 161792
  s_mov_b32 s4, 0
F_l11:
  ds_read_b64 v[6:7], v5 offset:40
  s_add_u32 s4, s4, 1
  s_waitcnt lgkmcnt(0)
  v_readfirstlane_b32 s62, v6
  v_readfirstlane_b32 s63, v7
  s_cmp_lg_u32 s62, 0
  s_cbranch_scc1 F_l11_ok
  s_cmp_lt_u32 s4, 1600000
  s_cbranch_scc1 F_l11

F_l11_ok:
  v_lshlrev_b32 v8, 7, v1
  v_mov_b32 v5, 161792
  s_mov_b32 s4, 0
F_l12:
  ds_read_b32 v4, v5 offset:24
  s_add_u32 s4, s4, 1
  s_waitcnt lgkmcnt(0)
  v_readfirstlane_b32 s3, v4
  s_cmp_ge_u32 s3, 4
  s_cbranch_scc1 F_l12_ok

  s_sleep 1
  s_cmp_lt_u32 s4, 1600000
  s_cbranch_scc1 F_l12

F_l12_ok:
  s_mov_b32 s3, 8052736
  s_mov_b32 s4, 0
  s_cmp_lg_u32 s9, 5
  s_cbranch_scc1 F_p1a
  buffer_load_dwordx4 v[92:95], v8, s[48:51], s3 offen sc1

F_p1a:
  s_setprio 0
  s_add_u32 m0, s12, 0
  s_nop 0
  buffer_load_dwordx4 v236, s[44:47], s14 offen lds
  s_add_u32 m0, s12, 1024
  s_nop 0
  buffer_load_dwordx4 v237, s[44:47], s14 offen lds
  s_add_u32 m0, s12, 2048
  s_nop 0
  buffer_load_dwordx4 v238, s[44:47], s14 offen lds
  s_add_u32 m0, s12, 3072
  s_nop 0
  buffer_load_dwordx4 v239, s[44:47], s14 offen lds
  s_add_u32 s14, s14, 122880
  s_cmp_eq_u32 s14, 2457600
  s_cselect_b32 s14, 0, s14
  s_add_u32 s19, s19, 1
  s_cmp_ge_u32 s19, 20
  s_cselect_b32 s46, 0, s46
  s_add_u32 m0, s12, 4096
  s_nop 0
  buffer_load_dwordx4 v236, s[44:47], s14 offen lds
  s_add_u32 m0, s12, 5120
  s_nop 0
  buffer_load_dwordx4 v237, s[44:47], s14 offen lds
  s_add_u32 m0, s12, 6144
  s_nop 0
  buffer_load_dwordx4 v238, s[44:47], s14 offen lds
  s_add_u32 m0, s12, 7168
  s_nop 0
  buffer_load_dwordx4 v239, s[44:47], s14 offen lds
  s_add_u32 s14, s14, 122880
  s_cmp_eq_u32 s14, 2457600
  s_cselect_b32 s14, 0, s14
  s_add_u32 s19, s19, 1
  s_cmp_ge_u32 s19, 20
  s_cselect_b32 s46, 0, s46
  s_cmp_lg_u32 s9, 5
  s_cbranch_scc1 F_p1ok
  s_add_u32 s4, s4, 1
  s_waitcnt vmcnt(8)
  v_cmp_eq_u64 vcc, s[62:63], v[92:93]
  v_cmp_eq_u64 s[56:57], s[62:63], v[94:95]
  s_and_b64 vcc, vcc, s[56:57]
  s_cmp_eq_u64 vcc, -1
  s_cbranch_scc1 F_p1g

F_p1:
  buffer_load_dwordx4 v[92:95], v8, s[48:51], s3 offen sc1
  s_add_u32 s4, s4, 1
  s_waitcnt vmcnt(0)
  v_cmp_eq_u64 vcc, s[62:63], v[92:93]
  v_cmp_eq_u64 s[56:57], s[62:63], v[94:95]
  s_and_b64 vcc, vcc, s[56:57]
  s_cmp_eq_u64 vcc, -1
  s_cbranch_scc1 F_p1g

  s_cmp_lt_u32 s4, 200000
  s_cbranch_scc1 F_p1

F_p1g:
  v_mov_b32 v4, 161792
  v_mov_b32 v5, 64
  ds_write_b32 v4, v5 offset:116

F_p1ok:
  s_waitcnt vmcnt(6)
  ds_read_b128 v[28:31], v16 offset:0
  ds_read_b128 v[32:35], v16 offset:4096
  ds_read_b64_tr_b16 v[60:61], v240 offset:0
  ds_read_b64_tr_b16 v[62:63], v240 offset:512
  ds_read_b64_tr_b16 v[64:65], v241 offset:0
  ds_read_b64_tr_b16 v[66:67], v241 offset:512
  s_cmp_ge_u32 s6, 16
  s_cselect_b32 s52, s24, s30
  s_cselect_b32 s53, s25, s31
  s_mov_b32 s54, 819200
  s_mov_b32 s55, 0x20000
  s_and_b32 s3, s6, 15
  s_lshl_b32 s3, s3, 2
  s_add_u32 s3, s3, s10
  s_mul_i32 s15, s3, 12800
  s_lshr_b32 s3, s8, 2
  s_mul_i32 s3, s3, 640
  s_add_u32 s15, s15, s3
  s_mov_b32 s20, 0
  v_mov_b32 v95, 161792
  s_cmp_lt_u32 s96, 4
  s_cselect_b32 s5, 0, 0
  v_lshlrev_b32 v92, 4, v1
  v_mov_b32 v93, 0x7fffff00
  v_cmp_gt_u32 vcc, 40, v1
  s_sub_u32 s15, s15, 0
  v_cndmask_b32 v92, v93, v92, vcc
  s_cmp_ge_u32 s8, 5
  s_cbranch_scc1 F_h1N

F_l13:
  s_cmp_lg_u32 s20, 7
  s_cbranch_scc1 F_l13npf
  s_call_b64 s[98:99], F_wpf
F_l13npf:
  s_waitcnt vmcnt(4) lgkmcnt(0)
  s_setprio 2
  v_mfma_f32_32x32x16_bf16 v[172:187], v[60:63], v[28:31], v[172:187]
  s_setprio 0
  ds_read_b64_tr_b16 v[68:69], v240 offset:2048
  ds_read_b64_tr_b16 v[70:71], v240 offset:2560
  ds_read_b64_tr_b16 v[72:73], v241 offset:2048
  ds_read_b64_tr_b16 v[74:75], v241 offset:2560
  s_setprio 2
  v_mfma_f32_32x32x16_bf16 v[188:203], v[64:67], v[28:31], v[188:203]
  s_setprio 0
  s_add_u32 m0, s12, 0
  ds_read_b128 v[36:39], v17 offset:0
  ds_read_b128 v[40:43], v17 offset:4096
  s_setprio 2
  v_mfma_f32_32x32x16_bf16 v[204:219], v[60:63], v[32:35], v[204:219]
  s_setprio 0
  buffer_load_dwordx4 v236, s[44:47], s14 offen lds
  s_add_u32 m0, s12, 1024
  s_setprio 2
  v_mfma_f32_32x32x16_bf16 v[220:235], v[64:67], v[32:35], v[220:235]
  s_setprio 0
  buffer_load_dwordx4 v237, s[44:47], s14 offen lds
  s_add_u32 s13, s13, 8192
  s_cmp_eq_u32 s13, 81920
  s_cselect_b32 s13, 0, s13
  s_add_u32 s20, s20, 1
  s_waitcnt vmcnt(4) lgkmcnt(0)
  s_setprio 2
  v_mfma_f32_32x32x16_bf16 v[172:187], v[68:71], v[36:39], v[172:187]
  s_setprio 0
  ds_read_b64_tr_b16 v[60:61], v240 offset:4096
  ds_read_b64_tr_b16 v[62:63], v240 offset:4608
  ds_read_b64_tr_b16 v[64:65], v241 offset:4096
  ds_read_b64_tr_b16 v[66:67], v241 offset:4608
  s_setprio 2
  v_mfma_f32_32x32x16_bf16 v[188:203], v[72:75], v[36:39], v[188:203]
  s_setprio 0
  s_add_u32 m0, s12, 2048
  ds_read_b128 v[28:31], v18 offset:0
  ds_read_b128 v[32:35], v18 offset:4096
  s_setprio 2
  v_mfma_f32_32x32x16_bf16 v[204:219], v[68:71], v[40:43], v[204:219]
  s_setprio 0
  buffer_load_dwordx4 v238, s[44:47], s14 offen lds
  s_add_u32 m0, s12, 3072
  s_setprio 2
  v_mfma_f32_32x32x16_bf16 v[220:235], v[72:75], v[40:43], v[220:235]
  s_setprio 0
  buffer_load_dwordx4 v239, s[44:47], s14 offen lds
  s_add_u32 s14, s14, 122880
  s_cmp_eq_u32 s14, 2457600
  s_cselect_b32 s14, 0, s14
  s_add_u32 s19, s19, 1
  s_cmp_ge_u32 s19, 20
  s_cselect_b32 s46, 0, s46
  s_waitcnt vmcnt(4) lgkmcnt(0)
  s_setprio 2
  v_mfma_f32_32x32x16_bf16 v[172:187], v[60:63], v[28:31], v[172:187]
  s_setprio 0
  ds_read_b64_tr_b16 v[68:69], v240 offset:6144
  ds_read_b64_tr_b16 v[70:71], v240 offset:6656
  ds_read_b64_tr_b16 v[72:73], v241 offset:6144
  ds_read_b64_tr_b16 v[74:75], v241 offset:6656
  s_setprio 2
  v_mfma_f32_32x32x16_bf16 v[188:203], v[64:67], v[28:31], v[188:203]
  s_setprio 0
  s_add_u32 m0, s12, 4096
  ds_read_b128 v[36:39], v19 offset:0
  ds_read_b128 v[40:43], v19 offset:4096
  s_setprio 2
  v_mfma_f32_32x32x16_bf16 v[204:219], v[60:63], v[32:35], v[204:219]
  s_setprio 0
  buffer_load_dwordx4 v236, s[44:47], s14 offen lds
  s_add_u32 m0, s12, 5120
  s_setprio 2
  v_mfma_f32_32x32x16_bf16 v[220:235], v[64:67], v[32:35], v[220:235]
  s_setprio 3
  v_add_u32 v16, s13, v12
  v_add_u32 v17, s13, v13
  v_add_u32 v18, s13, v14
  v_add_u32 v19, s13, v15
  s_setprio 0
  s_setprio 0
  buffer_load_dwordx4 v237, s[44:47], s14 offen lds
  s_waitcnt vmcnt(4) lgkmcnt(0)
  s_setprio 2
  v_mfma_f32_32x32x16_bf16 v[172:187], v[68:71], v[36:39], v[172:187]
  s_setprio 0
  ds_read_b64_tr_b16 v[60:61], v240 offset:0
  ds_read_b64_tr_b16 v[62:63], v240 offset:512
  ds_read_b64_tr_b16 v[64:65], v241 offset:0
  ds_read_b64_tr_b16 v[66:67], v241 offset:512
  s_setprio 2
  v_mfma_f32_32x32x16_bf16 v[188:203], v[72:75], v[36:39], v[188:203]
  s_setprio 0
  s_add_u32 m0, s12, 6144
  ds_read_b128 v[28:31], v16 offset:0
  ds_read_b128 v[32:35], v16 offset:4096
  s_setprio 2
  v_mfma_f32_32x32x16_bf16 v[204:219], v[68:71], v[40:43], v[204:219]
  s_setprio 0
  buffer_load_dwordx4 v238, s[44:47], s14 offen lds
  s_add_u32 m0, s12, 7168
  s_setprio 2
  v_mfma_f32_32x32x16_bf16 v[220:235], v[72:75], v[40:43], v[220:235]
  s_setprio 0
  buffer_load_dwordx4 v239, s[44:47], s14 offen lds
  s_add_u32 s14, s14, 122880
  s_cmp_eq_u32 s14, 2457600
  s_cselect_b32 s14, 0, s14
  s_add_u32 s19, s19, 1
  s_cmp_ge_u32 s19, 20
  s_cselect_b32 s46, 0, s46
  s_cmp_lt_u32 s20, 10
  s_cbranch_scc1 F_l13
  s_waitcnt vmcnt(0) lgkmcnt(0)
  s_setprio 3

  v_mov_b32 v4, 161792
  v_mov_b32 v5, 1
  s_mov_b64 exec, 1
  ds_add_u32 v4, v5 offset:36
  s_mov_b64 exec, -1

  v_lshlrev_b32 v104, 4, v1
  s_mul_i32 s3, s7, 163840
  s_mul_i32 s4, s8, 5120
  s_add_u32 s3, s3, s4
  v_mov_b64 v[100:101], -1
  v_mov_b64 v[102:103], -1
  s_and_b32 s4, s10, 1
  s_mul_i32 s4, s4, 81920
  s_add_u32 s3, s3, s4
  s_lshr_b32 s4, s10, 1
  s_lshl_b32 s4, s4, 11
  s_add_u32 s3, s3, 8257536
  s_add_u32 s42, s4, s3
  s_add_u32 s43, s42, 40960

  v_cvt_pk_bf16_f32 v172, v172, v173
  v_cvt_pk_bf16_f32 v173, v174, v175
  v_cvt_pk_bf16_f32 v174, v176, v177
  v_cvt_pk_bf16_f32 v175, v178, v179
  v_cvt_pk_bf16_f32 v176, v180, v181
  v_cvt_pk_bf16_f32 v177, v182, v183
  v_cvt_pk_bf16_f32 v178, v184, v185
  v_cvt_pk_bf16_f32 v179, v186, v187
  v_cvt_pk_bf16_f32 v188, v188, v189
  v_cvt_pk_bf16_f32 v189, v190, v191
  v_cvt_pk_bf16_f32 v190, v192, v193
  v_cvt_pk_bf16_f32 v191, v194, v195
  v_cvt_pk_bf16_f32 v192, v196, v197
  v_cvt_pk_bf16_f32 v193, v198, v199
  v_cvt_pk_bf16_f32 v194, v200, v201
  v_cvt_pk_bf16_f32 v195, v202, v203
  v_cvt_pk_bf16_f32 v204, v204, v205
  v_cvt_pk_bf16_f32 v205, v206, v207
  v_cvt_pk_bf16_f32 v206, v208, v209
  v_cvt_pk_bf16_f32 v207, v210, v211
  v_cvt_pk_bf16_f32 v208, v212, v213
  v_cvt_pk_bf16_f32 v209, v214, v215
  v_cvt_pk_bf16_f32 v210, v216, v217
  v_cvt_pk_bf16_f32 v211, v218, v219
  v_cvt_pk_bf16_f32 v220, v220, v221
  v_cvt_pk_bf16_f32 v221, v222, v223
  v_cvt_pk_bf16_f32 v222, v224, v225
  v_cvt_pk_bf16_f32 v223, v226, v227
  v_cvt_pk_bf16_f32 v224, v228, v229
  v_cvt_pk_bf16_f32 v225, v230, v231
  v_cvt_pk_bf16_f32 v226, v232, v233
  v_cvt_pk_bf16_f32 v227, v234, v235
  s_setprio 0
  s_lshl_b32 s3, s7, 1
  s_mul_i32 s3, s3, 81920
  s_lshl_b32 s4, s11, 5
  s_add_u32 s3, s3, s4
  s_add_u32 s4, s3, 81920

  buffer_store_dwordx4 v[172:175], v104, s[48:51], s3 offen offset:0 sc1
  buffer_store_dwordx4 v[176:179], v104, s[48:51], s3 offen offset:1024 sc1
  buffer_store_dwordx4 v[188:191], v104, s[48:51], s3 offen offset:2048 sc1
  buffer_store_dwordx4 v[192:195], v104, s[48:51], s3 offen offset:3072 sc1
  buffer_store_dwordx4 v[204:207], v104, s[48:51], s4 offen offset:0 sc1
  buffer_store_dwordx4 v[208:211], v104, s[48:51], s4 offen offset:1024 sc1
  buffer_store_dwordx4 v[220:223], v104, s[48:51], s4 offen offset:2048 sc1
  buffer_store_dwordx4 v[224:227], v104, s[48:51], s4 offen offset:3072 sc1
  s_branch F_h1done
F_h1N:
F_l14:
  s_cmp_lg_u32 s20, 7
  s_cbranch_scc1 F_l14npf
  s_call_b64 s[98:99], F_wpf
F_l14npf:
  s_waitcnt vmcnt(4) lgkmcnt(0)
  s_setprio 2
  v_mfma_f32_32x32x16_bf16 v[172:187], v[28:31], v[60:63], v[172:187]
  s_setprio 0
  ds_read_b64_tr_b16 v[68:69], v240 offset:2048
  ds_read_b64_tr_b16 v[70:71], v240 offset:2560
  ds_read_b64_tr_b16 v[72:73], v241 offset:2048
  ds_read_b64_tr_b16 v[74:75], v241 offset:2560
  s_setprio 2
  v_mfma_f32_32x32x16_bf16 v[188:203], v[28:31], v[64:67], v[188:203]
  s_setprio 0
  s_add_u32 m0, s12, 0
  ds_read_b128 v[36:39], v17 offset:0
  ds_read_b128 v[40:43], v17 offset:4096
  s_setprio 2
  v_mfma_f32_32x32x16_bf16 v[204:219], v[32:35], v[60:63], v[204:219]
  s_setprio 0
  buffer_load_dwordx4 v236, s[44:47], s14 offen lds
  s_add_u32 m0, s12, 1024
  s_setprio 2
  v_mfma_f32_32x32x16_bf16 v[220:235], v[32:35], v[64:67], v[220:235]
  s_setprio 0
  buffer_load_dwordx4 v237, s[44:47], s14 offen lds
  s_add_u32 s13, s13, 8192
  s_cmp_eq_u32 s13, 81920
  s_cselect_b32 s13, 0, s13
  s_add_u32 s20, s20, 1
  s_waitcnt vmcnt(4) lgkmcnt(0)
  s_setprio 2
  v_mfma_f32_32x32x16_bf16 v[172:187], v[36:39], v[68:71], v[172:187]
  s_setprio 0
  ds_read_b64_tr_b16 v[60:61], v240 offset:4096
  ds_read_b64_tr_b16 v[62:63], v240 offset:4608
  ds_read_b64_tr_b16 v[64:65], v241 offset:4096
  ds_read_b64_tr_b16 v[66:67], v241 offset:4608
  s_setprio 2
  v_mfma_f32_32x32x16_bf16 v[188:203], v[36:39], v[72:75], v[188:203]
  s_setprio 0
  s_add_u32 m0, s12, 2048
  ds_read_b128 v[28:31], v18 offset:0
  ds_read_b128 v[32:35], v18 offset:4096
  s_setprio 2
  v_mfma_f32_32x32x16_bf16 v[204:219], v[40:43], v[68:71], v[204:219]
  s_setprio 0
  buffer_load_dwordx4 v238, s[44:47], s14 offen lds
  s_add_u32 m0, s12, 3072
  s_setprio 2
  v_mfma_f32_32x32x16_bf16 v[220:235], v[40:43], v[72:75], v[220:235]
  s_setprio 0
  buffer_load_dwordx4 v239, s[44:47], s14 offen lds
  s_add_u32 s14, s14, 122880
  s_cmp_eq_u32 s14, 2457600
  s_cselect_b32 s14, 0, s14
  s_add_u32 s19, s19, 1
  s_cmp_ge_u32 s19, 20
  s_cselect_b32 s46, 0, s46
  s_waitcnt vmcnt(4) lgkmcnt(0)
  s_setprio 2
  v_mfma_f32_32x32x16_bf16 v[172:187], v[28:31], v[60:63], v[172:187]
  s_setprio 0
  ds_read_b64_tr_b16 v[68:69], v240 offset:6144
  ds_read_b64_tr_b16 v[70:71], v240 offset:6656
  ds_read_b64_tr_b16 v[72:73], v241 offset:6144
  ds_read_b64_tr_b16 v[74:75], v241 offset:6656
  s_setprio 2
  v_mfma_f32_32x32x16_bf16 v[188:203], v[28:31], v[64:67], v[188:203]
  s_setprio 0
  s_add_u32 m0, s12, 4096
  ds_read_b128 v[36:39], v19 offset:0
  ds_read_b128 v[40:43], v19 offset:4096
  s_setprio 2
  v_mfma_f32_32x32x16_bf16 v[204:219], v[32:35], v[60:63], v[204:219]
  s_setprio 0
  buffer_load_dwordx4 v236, s[44:47], s14 offen lds
  s_add_u32 m0, s12, 5120
  s_setprio 2
  v_mfma_f32_32x32x16_bf16 v[220:235], v[32:35], v[64:67], v[220:235]
  s_setprio 3
  v_add_u32 v16, s13, v12
  v_add_u32 v17, s13, v13
  v_add_u32 v18, s13, v14
  v_add_u32 v19, s13, v15
  s_setprio 0
  s_setprio 0
  buffer_load_dwordx4 v237, s[44:47], s14 offen lds
  s_waitcnt vmcnt(4) lgkmcnt(0)
  s_setprio 2
  v_mfma_f32_32x32x16_bf16 v[172:187], v[36:39], v[68:71], v[172:187]
  s_setprio 0
  ds_read_b64_tr_b16 v[60:61], v240 offset:0
  ds_read_b64_tr_b16 v[62:63], v240 offset:512
  ds_read_b64_tr_b16 v[64:65], v241 offset:0
  ds_read_b64_tr_b16 v[66:67], v241 offset:512
  s_setprio 2
  v_mfma_f32_32x32x16_bf16 v[188:203], v[36:39], v[72:75], v[188:203]
  s_setprio 0
  s_add_u32 m0, s12, 6144
  ds_read_b128 v[28:31], v16 offset:0
  ds_read_b128 v[32:35], v16 offset:4096
  s_setprio 2
  v_mfma_f32_32x32x16_bf16 v[204:219], v[40:43], v[68:71], v[204:219]
  s_setprio 0
  buffer_load_dwordx4 v238, s[44:47], s14 offen lds
  s_add_u32 m0, s12, 7168
  s_setprio 2
  v_mfma_f32_32x32x16_bf16 v[220:235], v[40:43], v[72:75], v[220:235]
  s_setprio 0
  buffer_load_dwordx4 v239, s[44:47], s14 offen lds
  s_add_u32 s14, s14, 122880
  s_cmp_eq_u32 s14, 2457600
  s_cselect_b32 s14, 0, s14
  s_add_u32 s19, s19, 1
  s_cmp_ge_u32 s19, 20
  s_cselect_b32 s46, 0, s46
  s_cmp_lt_u32 s20, 10
  s_cbranch_scc1 F_l14
  s_waitcnt vmcnt(0) lgkmcnt(0)
  s_setprio 3

  v_mov_b32 v4, 161792
  v_mov_b32 v5, 1
  s_mov_b64 exec, 1
  ds_add_u32 v4, v5 offset:36
  s_mov_b64 exec, -1

  v_lshlrev_b32 v104, 4, v1
  s_mul_i32 s3, s7, 163840
  s_mul_i32 s4, s8, 5120
  s_add_u32 s3, s3, s4
  v_mov_b64 v[100:101], -1
  v_mov_b64 v[102:103], -1
  s_and_b32 s4, s10, 1
  s_mul_i32 s4, s4, 81920
  s_add_u32 s3, s3, s4
  s_lshr_b32 s4, s10, 1
  s_lshl_b32 s4, s4, 11
  s_add_u32 s3, s3, 8257536
  s_add_u32 s42, s4, s3
  s_add_u32 s43, s42, 40960

  v_cvt_pk_bf16_f32 v172, v172, v173
  v_cvt_pk_bf16_f32 v173, v174, v175
  v_cvt_pk_bf16_f32 v174, v176, v177
  v_cvt_pk_bf16_f32 v175, v178, v179
  v_cvt_pk_bf16_f32 v176, v180, v181
  v_cvt_pk_bf16_f32 v177, v182, v183
  v_cvt_pk_bf16_f32 v178, v184, v185
  v_cvt_pk_bf16_f32 v179, v186, v187
  v_cvt_pk_bf16_f32 v188, v188, v189
  v_cvt_pk_bf16_f32 v189, v190, v191
  v_cvt_pk_bf16_f32 v190, v192, v193
  v_cvt_pk_bf16_f32 v191, v194, v195
  v_cvt_pk_bf16_f32 v192, v196, v197
  v_cvt_pk_bf16_f32 v193, v198, v199
  v_cvt_pk_bf16_f32 v194, v200, v201
  v_cvt_pk_bf16_f32 v195, v202, v203
  v_cvt_pk_bf16_f32 v204, v204, v205
  v_cvt_pk_bf16_f32 v205, v206, v207
  v_cvt_pk_bf16_f32 v206, v208, v209
  v_cvt_pk_bf16_f32 v207, v210, v211
  v_cvt_pk_bf16_f32 v208, v212, v213
  v_cvt_pk_bf16_f32 v209, v214, v215
  v_cvt_pk_bf16_f32 v210, v216, v217
  v_cvt_pk_bf16_f32 v211, v218, v219
  v_cvt_pk_bf16_f32 v220, v220, v221
  v_cvt_pk_bf16_f32 v221, v222, v223
  v_cvt_pk_bf16_f32 v222, v224, v225
  v_cvt_pk_bf16_f32 v223, v226, v227
  v_cvt_pk_bf16_f32 v224, v228, v229
  v_cvt_pk_bf16_f32 v225, v230, v231
  v_cvt_pk_bf16_f32 v226, v232, v233
  v_cvt_pk_bf16_f32 v227, v234, v235
  s_setprio 0
  s_cmp_ge_u32 s11, 3840
  s_cbranch_scc1 F_h1done
  s_sub_u32 s3, s11, 2560
  s_lshl_b32 s3, s3, 11
  s_lshl_b32 s4, s7, 12
  s_add_u32 s3, s3, s4
  s_add_u32 s3, s3, 5242880
  s_add_u32 s4, s3, 131072

  buffer_store_dwordx4 v[172:175], v104, s[48:51], s3 offen offset:0 sc1
  buffer_store_dwordx4 v[176:179], v104, s[48:51], s3 offen offset:1024 sc1
  buffer_store_dwordx4 v[188:191], v104, s[48:51], s4 offen offset:0 sc1
  buffer_store_dwordx4 v[192:195], v104, s[48:51], s4 offen offset:1024 sc1
  buffer_store_dwordx4 v[204:207], v104, s[48:51], s3 offen offset:2048 sc1
  buffer_store_dwordx4 v[208:211], v104, s[48:51], s3 offen offset:3072 sc1
  buffer_store_dwordx4 v[220:223], v104, s[48:51], s4 offen offset:2048 sc1
  buffer_store_dwordx4 v[224:227], v104, s[48:51], s4 offen offset:3072 sc1
F_h1done:
  buffer_store_dwordx4 v[100:103], v104, s[48:51], s43 offen offset:0 sc1
  buffer_store_dwordx4 v[100:103], v104, s[48:51], s43 offen offset:1024 sc1
  buffer_store_dwordx4 v[100:103], v104, s[48:51], s43 offen offset:2048 sc1
  s_setprio 1
  s_mov_b32 s44, s30
  s_mov_b32 s45, s31
  s_mov_b32 s46, 819200
  s_mov_b32 s47, 0x20000
  s_lshl_b32 s12, s10, 10
  s_mul_i32 s22, s7, 6144
  s_add_u32 s22, s22, 8060928
  s_lshl_b32 s3, s8, 7
  s_add_u32 s23, s22, s3
  s_and_b32 s13, s7, 7
  s_cmp_ge_u32 s13, 5
  s_cselect_b32 s3, 5, 0
  s_sub_u32 s13, s13, s3
  s_mov_b32 s14, 2
  s_mov_b32 s15, 0
  s_lshl_b32 s3, s7, 1
  s_mul_i32 s29, s3, 81920
  s_add_u32 s30, s29, 81920
  s_add_u32 s31, s29, 40960
  s_add_u32 s32, s30, 40960
  s_sub_u32 s33, s31, 81920
  s_lshl_b32 s26, s7, 12
  s_add_u32 s26, s26, 5242880
  s_sub_u32 s27, s26, 1024
  s_sub_u32 s28, s22, 6144
  s_cmp_eq_u32 s7, 0
  s_cselect_b32 s33, s31, s33
  s_cselect_b32 s27, s26, s27
  s_cselect_b32 s28, s22, s28
  s_lshl_b32 s18, s7, 8
  s_add_u32 s18, s18, 8044544

  s_waitcnt vmcnt(0)
  v_mov_b32 v4, 161792
  v_mov_b32 v5, 1
  s_mov_b64 exec, 1
  ds_add_rtn_u32 v5, v4, v5 offset:48
  v_mov_b32 v4, 0
  v_mov_b32 v6, s62
  v_mov_b32 v7, s63
  s_waitcnt lgkmcnt(0)
  v_cmp_eq_u32 vcc, 3, v5
  s_cbranch_vccz F_l15
  buffer_store_dwordx2 v[6:7], v4, s[48:51], s23 offen offset:0 sc1

F_l15:
  s_mov_b64 exec, -1
  v_mov_b32 v7, 161792
  s_mov_b32 s4, 0
F_l16:
  ds_read_b32 v6, v7 offset:36
  s_add_u32 s4, s4, 1
  s_waitcnt lgkmcnt(0)
  v_readfirstlane_b32 s3, v6
  s_cmp_ge_u32 s3, 8
  s_cbranch_scc1 F_l16_ok

  s_setprio 1
  s_sleep 1
  s_cmp_lt_u32 s4, 1600000
  s_cbranch_scc1 F_l16

F_l16_ok:
  s_setprio 1
F_l17:
  s_call_b64 s[98:99], F_wob
  s_cmp_lt_u32 s15, 2
  s_cbranch_scc1 F_l17

  s_setprio 0
  buffer_store_dwordx4 v[100:103], v104, s[48:51], s42 offen offset:0 sc1
  buffer_store_dwordx4 v[100:103], v104, s[48:51], s42 offen offset:1024 sc1
  buffer_store_dwordx4 v[100:103], v104, s[48:51], s42 offen offset:2048 sc1
  s_setprio 1
  s_cmp_lg_u32 s9, 4
  s_cbranch_scc1 F_l18
  s_mov_b32 s19, 0
F_l19:
  buffer_load_dwordx2 v[6:7], v242, s[48:51], s28 offen sc1
  s_add_u32 s19, s19, 1
  s_waitcnt vmcnt(0)
  v_cmp_ne_u64 vcc, s[62:63], v[6:7]

  s_cbranch_vccz F_l19_ok
  s_sleep 2
  s_cmp_lt_u32 s19, 200000
  s_cbranch_scc1 F_l19

F_l19_ok:
  v_mov_b32 v4, 161792
  v_mov_b32 v5, 1
  s_mov_b64 exec, 1
  ds_add_u32 v4, v5 offset:64
  s_mov_b64 exec, -1

  s_branch F_l18_ok
F_l18:
  v_mov_b32 v7, 161792
  s_mov_b32 s19, 0
  s_waitcnt vmcnt(0)
F_l18_w:
  ds_read_b32 v6, v7 offset:64
  s_add_u32 s19, s19, 1
  s_waitcnt lgkmcnt(0)
  v_readfirstlane_b32 s3, v6
  s_cmp_lg_u32 s3, 0
  s_cbranch_scc1 F_l18_ok
  s_setprio 1
  s_sleep 1
  s_cmp_lt_u32 s19, 1600000
  s_cbranch_scc1 F_l18_w

F_l18_ok:
  s_setprio 0
  buffer_load_dwordx4 v[28:31], v148, s[48:51], s29 offen offset:0 sc1
  buffer_load_dwordx4 v[32:35], v148, s[48:51], s29 offen offset:256 sc1
  buffer_load_dwordx4 v[36:39], v148, s[48:51], s30 offen offset:0 sc1
  buffer_load_dwordx4 v[40:43], v148, s[48:51], s30 offen offset:256 sc1
  buffer_load_dwordx4 v[44:47], v148, s[48:51], s33 offen offset:256 sc1
  buffer_load_dwordx4 v[48:51], v148, s[48:51], s31 offen offset:0 sc1
  buffer_load_dwordx4 v[52:55], v148, s[48:51], s31 offen offset:256 sc1
  buffer_load_dwordx4 v[56:59], v148, s[48:51], s32 offen offset:0 sc1
  buffer_load_dwordx4 v[60:63], v148, s[48:51], s32 offen offset:256 sc1
  buffer_load_dwordx2 v[64:65], v150, s[48:51], s27 offen offset:0 sc1
  buffer_load_dwordx2 v[66:67], v150, s[48:51], s26 offen offset:0 sc1
  buffer_load_dwordx2 v[68:69], v150, s[48:51], s26 offen offset:1024 sc1
  buffer_load_dwordx2 v[70:71], v150, s[48:51], s26 offen offset:2048 sc1
  buffer_load_dwordx2 v[72:73], v150, s[48:51], s26 offen offset:3072 sc1
  buffer_load_dwordx2 v[74:75], v151, s[48:51], s27 offen offset:0 sc1
  buffer_load_dwordx2 v[76:77], v151, s[48:51], s26 offen offset:0 sc1
  buffer_load_dwordx2 v[78:79], v151, s[48:51], s26 offen offset:1024 sc1
  buffer_load_dwordx2 v[80:81], v151, s[48:51], s26 offen offset:2048 sc1
  buffer_load_dwordx2 v[82:83], v151, s[48:51], s26 offen offset:3072 sc1
  buffer_load_dword v84, v152, s[48:51], s18 offen offset:0 sc1
  buffer_load_dword v85, v152, s[48:51], s18 offen offset:64 sc1
  buffer_load_dword v86, v152, s[48:51], s18 offen offset:128 sc1
  buffer_load_dword v87, v152, s[48:51], s18 offen offset:192 sc1
  s_setprio 3
  s_lshl_b32 s3, s7, 1
  s_mul_i32 s36, s3, 81920
  s_mul_i32 s3, s8, 5120
  s_add_u32 s36, s36, s3
  s_add_u32 s36, s36, 8298496
  s_lshl_b32 s3, s10, 10
  s_add_u32 s37, s36, s3
  s_add_u32 s38, s37, 81920
  s_lshr_b32 s3, s10, 1
  s_lshl_b32 s3, s3, 9
  s_and_b32 s4, s10, 1
  s_lshl_b32 s4, s4, 3
  s_add_u32 s3, s3, s4
  s_add_u32 s40, s36, s3
  s_add_u32 s40, s40, 4096
  s_add_u32 s41, s40, 81920
  v_mov_b32 v8, 0x3ea52b5c
  v_mov_b32 v9, 0xbea52b5c

  s_add_u32 s3, s15, s13
  s_cmp_ge_u32 s3, 5
  s_cselect_b32 s4, 5, 0
  s_sub_u32 s3, s3, s4
  s_mul_i32 s42, s3, 163840
  s_mul_i32 s43, s3, 20480
  s_add_u32 s43, s43, s12
  s_add_u32 s15, s15, 1
  s_mov_b32 s14, 5

  s_waitcnt vmcnt(19)
  v_and_b32 v28, v149, v28
  v_and_b32 v29, v149, v29
  v_and_b32 v30, v155, v30
  v_and_b32 v31, v155, v31
  v_and_b32 v32, v149, v32
  v_and_b32 v33, v149, v33
  v_and_b32 v34, v155, v34
  v_and_b32 v35, v155, v35
  v_and_b32 v36, v149, v36
  v_and_b32 v37, v149, v37
  v_and_b32 v38, v155, v38
  v_and_b32 v39, v155, v39
  v_and_b32 v40, v149, v40
  v_and_b32 v41, v149, v41
  v_and_b32 v42, v155, v42
  v_and_b32 v43, v155, v43
  s_waitcnt vmcnt(14)
  s_setprio 1
  v_mfma_f32_16x16x32_bf16 v[88:91], v[44:47], v[28:31], v[164:167]
  v_mfma_f32_16x16x32_bf16 v[92:95], v[48:51], v[28:31], v[156:159]
  v_mfma_f32_16x16x32_bf16 v[96:99], v[48:51], v[32:35], v[160:163]
  v_mfma_f32_16x16x32_bf16 v[100:103], v[52:55], v[32:35], v[156:159]
  v_mfma_f32_16x16x32_bf16 v[104:107], v[52:55], v[36:39], v[160:163]
  v_mfma_f32_16x16x32_bf16 v[108:111], v[56:59], v[36:39], v[156:159]
  v_mfma_f32_16x16x32_bf16 v[112:115], v[56:59], v[40:43], v[160:163]
  v_mfma_f32_16x16x32_bf16 v[116:119], v[60:63], v[40:43], v[156:159]
  s_add_u32 m0, s43, 0
  s_setprio 0
  buffer_load_dwordx4 v244, s[44:47], s42 offen lds
  s_setprio 3
  s_nop 3
  v_max3_f32 v136, v88, v89, v90
  v_max3_f32 v136, v136, v91, v92
  v_max3_f32 v136, v136, v93, v94
  v_max_f32 v136, v136, v95
  v_mov_b32 v137, v136

  v_max3_f32 v138, v96, v97, v98
  v_max3_f32 v138, v138, v99, v100
  v_max3_f32 v138, v138, v101, v102
  v_max_f32 v138, v138, v103
  v_mov_b32 v139, v138

  v_max3_f32 v140, v104, v105, v106
  v_max3_f32 v140, v140, v107, v108
  v_max3_f32 v140, v140, v109, v110
  v_max_f32 v140, v140, v111
  v_mov_b32 v141, v140

  v_max3_f32 v142, v112, v113, v114
  v_max3_f32 v142, v142, v115, v116
  v_max3_f32 v142, v142, v117, v118
  v_max_f32 v142, v142, v119
  v_mov_b32 v143, v142

  s_nop 1
  v_permlane16_swap_b32 v136, v137
  v_permlane16_swap_b32 v138, v139
  v_permlane16_swap_b32 v140, v141
  v_permlane16_swap_b32 v142, v143
  v_max_f32 v136, v136, v137
  v_max_f32 v138, v138, v139
  v_max_f32 v140, v140, v141
  v_max_f32 v142, v142, v143
  v_mov_b32 v137, v136
  v_mov_b32 v139, v138
  v_mov_b32 v141, v140
  v_mov_b32 v143, v142
  s_nop 1
  v_permlane32_swap_b32 v136, v137
  v_permlane32_swap_b32 v138, v139
  v_permlane32_swap_b32 v140, v141
  v_permlane32_swap_b32 v142, v143
  v_max_f32 v136, v136, v137
  v_max_f32 v138, v138, v139
  v_max_f32 v140, v140, v141
  v_max_f32 v142, v142, v143
  v_mul_f32 v136, v9, v136
  v_mul_f32 v138, v9, v138
  v_mul_f32 v140, v9, v140
  v_mul_f32 v142, v9, v142
  v_pk_fma_f32 v[88:89], v[88:89], v[8:9], v[136:137] op_sel_hi:[1,0,0]
  v_pk_fma_f32 v[90:91], v[90:91], v[8:9], v[136:137] op_sel_hi:[1,0,0]
  v_pk_fma_f32 v[92:93], v[92:93], v[8:9], v[136:137] op_sel_hi:[1,0,0]
  v_pk_fma_f32 v[94:95], v[94:95], v[8:9], v[136:137] op_sel_hi:[1,0,0]
  v_exp_f32 v88, v88
  v_exp_f32 v89, v89
  v_exp_f32 v90, v90
  v_exp_f32 v91, v91
  v_exp_f32 v92, v92
  v_exp_f32 v93, v93
  v_exp_f32 v94, v94
  v_exp_f32 v95, v95
  s_add_u32 m0, s43, 4096
  s_setprio 0
  buffer_load_dwordx4 v245, s[44:47], s42 offen lds
  s_setprio 3
  v_pk_fma_f32 v[96:97], v[96:97], v[8:9], v[138:139] op_sel_hi:[1,0,0]
  v_pk_fma_f32 v[98:99], v[98:99], v[8:9], v[138:139] op_sel_hi:[1,0,0]
  v_pk_fma_f32 v[100:101], v[100:101], v[8:9], v[138:139] op_sel_hi:[1,0,0]
  v_pk_fma_f32 v[102:103], v[102:103], v[8:9], v[138:139] op_sel_hi:[1,0,0]
  v_exp_f32 v96, v96
  v_exp_f32 v97, v97
  v_exp_f32 v98, v98
  v_exp_f32 v99, v99
  v_exp_f32 v100, v100
  v_exp_f32 v101, v101
  v_exp_f32 v102, v102
  v_exp_f32 v103, v103
  v_pk_fma_f32 v[104:105], v[104:105], v[8:9], v[140:141] op_sel_hi:[1,0,0]
  v_pk_fma_f32 v[106:107], v[106:107], v[8:9], v[140:141] op_sel_hi:[1,0,0]
  v_pk_fma_f32 v[108:109], v[108:109], v[8:9], v[140:141] op_sel_hi:[1,0,0]
  v_pk_fma_f32 v[110:111], v[110:111], v[8:9], v[140:141] op_sel_hi:[1,0,0]
  v_exp_f32 v104, v104
  v_exp_f32 v105, v105
  v_exp_f32 v106, v106
  v_exp_f32 v107, v107
  v_exp_f32 v108, v108
  v_exp_f32 v109, v109
  v_exp_f32 v110, v110
  v_exp_f32 v111, v111
  s_add_u32 m0, s43, 8192
  s_setprio 0
  buffer_load_dwordx4 v246, s[44:47], s42 offen lds
  s_setprio 3
  v_pk_fma_f32 v[112:113], v[112:113], v[8:9], v[142:143] op_sel_hi:[1,0,0]
  v_pk_fma_f32 v[114:115], v[114:115], v[8:9], v[142:143] op_sel_hi:[1,0,0]
  v_pk_fma_f32 v[116:117], v[116:117], v[8:9], v[142:143] op_sel_hi:[1,0,0]
  v_pk_fma_f32 v[118:119], v[118:119], v[8:9], v[142:143] op_sel_hi:[1,0,0]
  v_exp_f32 v112, v112
  v_exp_f32 v113, v113
  v_exp_f32 v114, v114
  v_exp_f32 v115, v115
  v_exp_f32 v116, v116
  v_exp_f32 v117, v117
  v_exp_f32 v118, v118
  v_exp_f32 v119, v119
  s_nop 0
  v_cvt_pk_bf16_f32 v120, v88, v89
  v_cvt_pk_bf16_f32 v121, v90, v91
  v_cvt_pk_bf16_f32 v122, v92, v93
  v_cvt_pk_bf16_f32 v123, v94, v95
  v_cvt_pk_bf16_f32 v124, v96, v97
  v_cvt_pk_bf16_f32 v125, v98, v99
  v_cvt_pk_bf16_f32 v126, v100, v101
  v_cvt_pk_bf16_f32 v127, v102, v103
  v_cvt_pk_bf16_f32 v128, v104, v105
  v_cvt_pk_bf16_f32 v129, v106, v107
  v_cvt_pk_bf16_f32 v130, v108, v109
  v_cvt_pk_bf16_f32 v131, v110, v111
  v_cvt_pk_bf16_f32 v132, v112, v113
  v_cvt_pk_bf16_f32 v133, v114, v115
  v_cvt_pk_bf16_f32 v134, v116, v117
  v_cvt_pk_bf16_f32 v135, v118, v119
  s_waitcnt vmcnt(3)
  v_add_u32 v6, 163328, v152
  s_setprio 1
  v_mfma_f32_16x16x32_bf16 v[204:207], v[168:171], v[120:123], 0
  v_mfma_f32_16x16x32_bf16 v[172:175], v[64:67], v[120:123], 0
  v_mfma_f32_16x16x32_bf16 v[176:179], v[74:77], v[120:123], 0
  ds_write_b32 v6, v84 offset:0
  v_mfma_f32_16x16x32_bf16 v[208:211], v[168:171], v[124:127], 0
  v_mfma_f32_16x16x32_bf16 v[180:183], v[66:69], v[124:127], 0
  v_mfma_f32_16x16x32_bf16 v[184:187], v[76:79], v[124:127], 0
  ds_write_b32 v6, v85 offset:64
  v_mfma_f32_16x16x32_bf16 v[212:215], v[168:171], v[128:131], 0
  v_mfma_f32_16x16x32_bf16 v[188:191], v[68:71], v[128:131], 0
  v_mfma_f32_16x16x32_bf16 v[192:195], v[78:81], v[128:131], 0
  ds_write_b32 v6, v86 offset:128
  v_mfma_f32_16x16x32_bf16 v[216:219], v[168:171], v[132:135], 0
  v_mfma_f32_16x16x32_bf16 v[196:199], v[70:73], v[132:135], 0
  v_mfma_f32_16x16x32_bf16 v[200:203], v[80:83], v[132:135], 0
  ds_write_b32 v6, v87 offset:192
  s_setprio 3
  s_nop 3
  v_rcp_f32 v6, v204
  v_sub_f32 v7, 1.0, v84
  v_mul_f32 v6, v6, v7

  v_pk_mul_f32 v[172:173], v[172:173], v[6:7] op_sel_hi:[1,0]
  v_pk_mul_f32 v[174:175], v[174:175], v[6:7] op_sel_hi:[1,0]
  v_pk_mul_f32 v[176:177], v[176:177], v[6:7] op_sel_hi:[1,0]
  v_pk_mul_f32 v[178:179], v[178:179], v[6:7] op_sel_hi:[1,0]
  v_cvt_pk_bf16_f32 v88, v172, v173
  v_cvt_pk_bf16_f32 v89, v174, v175
  v_cvt_pk_bf16_f32 v172, v176, v177
  v_cvt_pk_bf16_f32 v173, v178, v179
  v_min_u32 v88, -2, v88
  v_min_u32 v89, -2, v89
  v_min_u32 v172, -2, v172
  v_min_u32 v173, -2, v173
  s_add_u32 m0, s43, 12288
  s_setprio 0
  buffer_load_dwordx4 v247, s[44:47], s42 offen lds
  s_setprio 3
  v_rcp_f32 v6, v208
  v_sub_f32 v7, 1.0, v85
  v_mul_f32 v6, v6, v7

  v_pk_mul_f32 v[180:181], v[180:181], v[6:7] op_sel_hi:[1,0]
  v_pk_mul_f32 v[182:183], v[182:183], v[6:7] op_sel_hi:[1,0]
  v_pk_mul_f32 v[184:185], v[184:185], v[6:7] op_sel_hi:[1,0]
  v_pk_mul_f32 v[186:187], v[186:187], v[6:7] op_sel_hi:[1,0]
  v_cvt_pk_bf16_f32 v90, v180, v181
  v_cvt_pk_bf16_f32 v91, v182, v183
  v_cvt_pk_bf16_f32 v180, v184, v185
  v_cvt_pk_bf16_f32 v181, v186, v187
  v_min_u32 v90, -2, v90
  v_min_u32 v91, -2, v91
  v_min_u32 v180, -2, v180
  v_min_u32 v181, -2, v181
  v_rcp_f32 v6, v212
  v_sub_f32 v7, 1.0, v86
  v_mul_f32 v6, v6, v7

  v_pk_mul_f32 v[188:189], v[188:189], v[6:7] op_sel_hi:[1,0]
  v_pk_mul_f32 v[190:191], v[190:191], v[6:7] op_sel_hi:[1,0]
  v_pk_mul_f32 v[192:193], v[192:193], v[6:7] op_sel_hi:[1,0]
  v_pk_mul_f32 v[194:195], v[194:195], v[6:7] op_sel_hi:[1,0]
  v_cvt_pk_bf16_f32 v92, v188, v189
  v_cvt_pk_bf16_f32 v93, v190, v191
  v_cvt_pk_bf16_f32 v188, v192, v193
  v_cvt_pk_bf16_f32 v189, v194, v195
  v_min_u32 v92, -2, v92
  v_min_u32 v93, -2, v93
  v_min_u32 v188, -2, v188
  v_min_u32 v189, -2, v189
  s_add_u32 m0, s43, 16384
  s_setprio 0
  buffer_load_dwordx4 v248, s[44:47], s42 offen lds
  s_setprio 3
  v_rcp_f32 v6, v216
  v_sub_f32 v7, 1.0, v87
  v_mul_f32 v6, v6, v7

  v_pk_mul_f32 v[196:197], v[196:197], v[6:7] op_sel_hi:[1,0]
  v_pk_mul_f32 v[198:199], v[198:199], v[6:7] op_sel_hi:[1,0]
  v_pk_mul_f32 v[200:201], v[200:201], v[6:7] op_sel_hi:[1,0]
  v_pk_mul_f32 v[202:203], v[202:203], v[6:7] op_sel_hi:[1,0]
  v_cvt_pk_bf16_f32 v94, v196, v197
  v_cvt_pk_bf16_f32 v95, v198, v199
  v_cvt_pk_bf16_f32 v196, v200, v201
  v_cvt_pk_bf16_f32 v197, v202, v203
  v_min_u32 v94, -2, v94
  v_min_u32 v95, -2, v95
  v_min_u32 v196, -2, v196
  v_min_u32 v197, -2, v197
  s_nop 1
  v_permlane32_swap_b32 v88, v90
  v_permlane32_swap_b32 v89, v91
  buffer_store_dwordx4 v[88:91], v154, s[48:51], s37 offen sc1
  v_permlane32_swap_b32 v92, v94
  v_permlane32_swap_b32 v93, v95
  buffer_store_dwordx4 v[92:95], v154, s[48:51], s38 offen sc1
  s_mov_b64 exec, 0xffff
  buffer_store_dwordx2 v[172:173], v153, s[48:51], s40 offen offset:0 sc1
  buffer_store_dwordx2 v[180:181], v153, s[48:51], s40 offen offset:256 sc1
  buffer_store_dwordx2 v[188:189], v153, s[48:51], s41 offen offset:0 sc1
  buffer_store_dwordx2 v[196:197], v153, s[48:51], s41 offen offset:256 sc1
  s_mov_b64 exec, -1
F_l20:
  s_call_b64 s[98:99], F_wob
  s_cmp_lt_u32 s15, 5
  s_cbranch_scc1 F_l20

  s_mov_b32 s44, s24
  s_mov_b32 s45, s25
  s_setprio 0
  s_setprio 1
  s_waitcnt vmcnt(0)
  v_mov_b32 v4, 161792
  v_mov_b32 v5, 1
  s_mov_b64 exec, 1
  ds_add_u32 v4, v5 offset:36
  s_mov_b64 exec, -1

  s_add_u32 s19, s21, 40960
  s_mov_b32 s18, 0
  s_setprio 0
  buffer_load_dwordx4 v[44:47], v254, s[48:51], s19 offen offset:0 sc1
  buffer_load_dwordx4 v[48:51], v254, s[48:51], s19 offen offset:2048 sc1
  s_add_u32 s19, s19, 4096
  buffer_load_dwordx4 v[52:55], v254, s[48:51], s19 offen offset:0 sc1
  buffer_load_dwordx4 v[56:59], v254, s[48:51], s19 offen offset:2048 sc1
  s_add_u32 s19, s19, 4096
  buffer_load_dwordx4 v[60:63], v254, s[48:51], s19 offen offset:0 sc1
  buffer_load_dwordx4 v[64:67], v254, s[48:51], s19 offen offset:2048 sc1
  s_add_u32 s19, s19, 4096
  buffer_load_dwordx4 v[68:71], v254, s[48:51], s19 offen offset:0 sc1
  buffer_load_dwordx4 v[72:75], v254, s[48:51], s19 offen offset:2048 sc1
  s_add_u32 s19, s19, 4096
  buffer_load_dwordx4 v[76:79], v254, s[48:51], s19 offen offset:0 sc1
  buffer_load_dwordx4 v[80:83], v254, s[48:51], s19 offen offset:2048 sc1
  s_add_u32 s19, s19, 4096
  buffer_load_dwordx4 v[84:87], v254, s[48:51], s19 offen offset:0 sc1
  buffer_load_dwordx4 v[88:91], v254, s[48:51], s19 offen offset:2048 sc1
  s_add_u32 s19, s19, 4096
  s_setprio 1
  s_setprio 3
  v_mov_b32 v8, 161792
  v_mov_b32 v9, 1
  v_mov_b32 v7, 161792
  s_mov_b32 s4, 0
F_l21:
  ds_read_b32 v6, v7 offset:36
  s_add_u32 s4, s4, 1
  s_waitcnt lgkmcnt(0)
  v_readfirstlane_b32 s3, v6
  s_cmp_ge_u32 s3, 12
  s_cbranch_scc1 F_l21_ok

  s_setprio 1
  s_sleep 1
  s_cmp_lt_u32 s4, 1600000
  s_cbranch_scc1 F_l21

F_l21_ok:
  s_setprio 1
  ds_read_b64_tr_b16 v[124:125], v249 offset:0
  ds_read_b64_tr_b16 v[126:127], v249 offset:1280
  ds_read_b64_tr_b16 v[128:129], v249 offset:32
  ds_read_b64_tr_b16 v[130:131], v249 offset:1312
  ds_read_b64_tr_b16 v[132:133], v249 offset:64
  ds_read_b64_tr_b16 v[134:135], v249 offset:1344
  ds_read_b64_tr_b16 v[136:137], v249 offset:96
  ds_read_b64_tr_b16 v[138:139], v249 offset:1376
  ds_read_b64_tr_b16 v[140:141], v249 offset:128
  ds_read_b64_tr_b16 v[142:143], v249 offset:1408
  ds_read_b64_tr_b16 v[144:145], v249 offset:6400
  ds_read_b64_tr_b16 v[146:147], v249 offset:7680
  ds_read_b64_tr_b16 v[148:149], v249 offset:6432
  ds_read_b64_tr_b16 v[150:151], v249 offset:7712
  ds_read_b64_tr_b16 v[152:153], v249 offset:6464
  ds_read_b64_tr_b16 v[154:155], v249 offset:7744
  ds_read_b64_tr_b16 v[156:157], v249 offset:6496
  ds_read_b64_tr_b16 v[158:159], v249 offset:7776
  ds_read_b64_tr_b16 v[160:161], v249 offset:6528
  ds_read_b64_tr_b16 v[162:163], v249 offset:7808
  ds_read_b64_tr_b16 v[164:165], v250 offset:0
  ds_read_b64_tr_b16 v[166:167], v251 offset:0
  ds_read_b64_tr_b16 v[168:169], v250 offset:32
  ds_read_b64_tr_b16 v[170:171], v251 offset:32
  ds_read_b64_tr_b16 v[172:173], v250 offset:64
  ds_read_b64_tr_b16 v[174:175], v251 offset:64
  ds_read_b64_tr_b16 v[176:177], v250 offset:96
  ds_read_b64_tr_b16 v[178:179], v251 offset:96
  ds_read_b64_tr_b16 v[180:181], v250 offset:128
  ds_read_b64_tr_b16 v[182:183], v251 offset:128
  ds_read_b64_tr_b16 v[184:185], v249 offset:16000
  ds_read_b64_tr_b16 v[186:187], v249 offset:17280
  ds_read_b64_tr_b16 v[188:189], v249 offset:16032
  ds_read_b64_tr_b16 v[190:191], v249 offset:17312
  ds_read_b64_tr_b16 v[192:193], v249 offset:16064
  ds_read_b64_tr_b16 v[194:195], v249 offset:17344
  ds_read_b64_tr_b16 v[196:197], v249 offset:16096
  ds_read_b64_tr_b16 v[198:199], v249 offset:17376
  ds_read_b64_tr_b16 v[200:201], v249 offset:16128
  ds_read_b64_tr_b16 v[202:203], v249 offset:17408
  ds_read_b64_tr_b16 v[204:205], v252 offset:0
  ds_read_b64_tr_b16 v[206:207], v253 offset:0
  ds_read_b64_tr_b16 v[208:209], v252 offset:32
  ds_read_b64_tr_b16 v[210:211], v253 offset:32
  ds_read_b64_tr_b16 v[212:213], v252 offset:64
  ds_read_b64_tr_b16 v[214:215], v253 offset:64
  ds_read_b64_tr_b16 v[216:217], v252 offset:96
  ds_read_b64_tr_b16 v[218:219], v253 offset:96
  ds_read_b64_tr_b16 v[220:221], v252 offset:128
  ds_read_b64_tr_b16 v[222:223], v253 offset:128
  ds_read_b64_tr_b16 v[224:225], v249 offset:25600
  ds_read_b64_tr_b16 v[226:227], v249 offset:26880
  ds_read_b64_tr_b16 v[228:229], v249 offset:25632
  ds_read_b64_tr_b16 v[230:231], v249 offset:26912
  ds_read_b64_tr_b16 v[232:233], v249 offset:25664
  ds_read_b64_tr_b16 v[234:235], v249 offset:26944
  ds_read_b64_tr_b16 v[236:237], v249 offset:25696
  ds_read_b64_tr_b16 v[238:239], v249 offset:26976
  ds_read_b64_tr_b16 v[240:241], v249 offset:25728
  ds_read_b64_tr_b16 v[242:243], v249 offset:27008
  s_waitcnt vmcnt(10) lgkmcnt(15)
F_hck0:
  s_setprio 3
  v_max3_u32 v4, v44, v45, v46
  v_max3_u32 v5, v47, v48, v49
  v_max3_u32 v4, v4, v50, v51
  v_max_u32 v4, v4, v5
  v_cmp_eq_u32 vcc, -1, v4
  s_setprio 1
  s_cbranch_vccnz F_hrt0

F_hgo0:
  v_mfma_f32_16x16x32_bf16 v[24:27], v[124:127], v[44:47], 0
  buffer_load_dwordx4 v[92:95], v254, s[48:51], s19 offen offset:0 sc1
  v_mfma_f32_16x16x32_bf16 v[28:31], v[128:131], v[44:47], 0
  v_mfma_f32_16x16x32_bf16 v[32:35], v[132:135], v[44:47], 0
  v_mfma_f32_16x16x32_bf16 v[36:39], v[136:139], v[44:47], 0
  v_mfma_f32_16x16x32_bf16 v[40:43], v[140:143], v[44:47], 0
  ds_read_b64_tr_b16 v[124:125], v249 offset:32000
  ds_read_b64_tr_b16 v[126:127], v249 offset:33280
  ds_read_b64_tr_b16 v[128:129], v249 offset:32032
  ds_read_b64_tr_b16 v[130:131], v249 offset:33312
  ds_read_b64_tr_b16 v[132:133], v249 offset:32064
  ds_read_b64_tr_b16 v[134:135], v249 offset:33344
  ds_read_b64_tr_b16 v[136:137], v249 offset:32096
  ds_read_b64_tr_b16 v[138:139], v249 offset:33376
  ds_read_b64_tr_b16 v[140:141], v249 offset:32128
  ds_read_b64_tr_b16 v[142:143], v249 offset:33408
  v_mfma_f32_16x16x32_bf16 v[24:27], v[144:147], v[48:51], v[24:27]
  buffer_load_dwordx4 v[96:99], v254, s[48:51], s19 offen offset:2048 sc1
  s_add_u32 s19, s19, 4096
  v_mfma_f32_16x16x32_bf16 v[28:31], v[148:151], v[48:51], v[28:31]
  v_mfma_f32_16x16x32_bf16 v[32:35], v[152:155], v[48:51], v[32:35]
  v_mfma_f32_16x16x32_bf16 v[36:39], v[156:159], v[48:51], v[36:39]
  v_mfma_f32_16x16x32_bf16 v[40:43], v[160:163], v[48:51], v[40:43]
  ds_read_b64_tr_b16 v[144:145], v250 offset:25600
  ds_read_b64_tr_b16 v[146:147], v251 offset:25600
  ds_read_b64_tr_b16 v[148:149], v250 offset:25632
  ds_read_b64_tr_b16 v[150:151], v251 offset:25632
  ds_read_b64_tr_b16 v[152:153], v250 offset:25664
  ds_read_b64_tr_b16 v[154:155], v251 offset:25664
  ds_read_b64_tr_b16 v[156:157], v250 offset:25696
  ds_read_b64_tr_b16 v[158:159], v251 offset:25696
  ds_read_b64_tr_b16 v[160:161], v250 offset:25728
  ds_read_b64_tr_b16 v[162:163], v251 offset:25728
  s_waitcnt vmcnt(10)
F_hck2:
  s_setprio 3
  v_max3_u32 v4, v52, v53, v54
  v_max3_u32 v5, v55, v56, v57
  v_max3_u32 v4, v4, v58, v59
  v_max_u32 v4, v4, v5
  v_cmp_eq_u32 vcc, -1, v4
  s_setprio 1
  s_cbranch_vccnz F_hrt2

F_hgo2:
  v_mfma_f32_16x16x32_bf16 v[24:27], v[164:167], v[52:55], v[24:27]
  buffer_load_dwordx4 v[100:103], v254, s[48:51], s19 offen offset:0 sc1
  v_mfma_f32_16x16x32_bf16 v[28:31], v[168:171], v[52:55], v[28:31]
  v_mfma_f32_16x16x32_bf16 v[32:35], v[172:175], v[52:55], v[32:35]
  v_mfma_f32_16x16x32_bf16 v[36:39], v[176:179], v[52:55], v[36:39]
  v_mfma_f32_16x16x32_bf16 v[40:43], v[180:183], v[52:55], v[40:43]
  ds_read_b64_tr_b16 v[164:165], v249 offset:41600
  ds_read_b64_tr_b16 v[166:167], v249 offset:42880
  ds_read_b64_tr_b16 v[168:169], v249 offset:41632
  ds_read_b64_tr_b16 v[170:171], v249 offset:42912
  ds_read_b64_tr_b16 v[172:173], v249 offset:41664
  ds_read_b64_tr_b16 v[174:175], v249 offset:42944
  ds_read_b64_tr_b16 v[176:177], v249 offset:41696
  ds_read_b64_tr_b16 v[178:179], v249 offset:42976
  ds_read_b64_tr_b16 v[180:181], v249 offset:41728
  ds_read_b64_tr_b16 v[182:183], v249 offset:43008
  v_mfma_f32_16x16x32_bf16 v[24:27], v[184:187], v[56:59], v[24:27]
  buffer_load_dwordx4 v[104:107], v254, s[48:51], s19 offen offset:2048 sc1
  s_add_u32 s19, s19, 4096
  v_mfma_f32_16x16x32_bf16 v[28:31], v[188:191], v[56:59], v[28:31]
  v_mfma_f32_16x16x32_bf16 v[32:35], v[192:195], v[56:59], v[32:35]
  v_mfma_f32_16x16x32_bf16 v[36:39], v[196:199], v[56:59], v[36:39]
  v_mfma_f32_16x16x32_bf16 v[40:43], v[200:203], v[56:59], v[40:43]
  ds_read_b64_tr_b16 v[184:185], v252 offset:25600
  ds_read_b64_tr_b16 v[186:187], v253 offset:25600
  ds_read_b64_tr_b16 v[188:189], v252 offset:25632
  ds_read_b64_tr_b16 v[190:191], v253 offset:25632
  ds_read_b64_tr_b16 v[192:193], v252 offset:25664
  ds_read_b64_tr_b16 v[194:195], v253 offset:25664
  ds_read_b64_tr_b16 v[196:197], v252 offset:25696
  ds_read_b64_tr_b16 v[198:199], v253 offset:25696
  ds_read_b64_tr_b16 v[200:201], v252 offset:25728
  ds_read_b64_tr_b16 v[202:203], v253 offset:25728
  s_waitcnt vmcnt(10) lgkmcnt(15)
F_hck4:
  s_setprio 3
  v_max3_u32 v4, v60, v61, v62
  v_max3_u32 v5, v63, v64, v65
  v_max3_u32 v4, v4, v66, v67
  v_max_u32 v4, v4, v5
  v_cmp_eq_u32 vcc, -1, v4
  s_setprio 1
  s_cbranch_vccnz F_hrt4

F_hgo4:
  v_mfma_f32_16x16x32_bf16 v[24:27], v[204:207], v[60:63], v[24:27]
  buffer_load_dwordx4 v[108:111], v254, s[48:51], s19 offen offset:0 sc1
  v_mfma_f32_16x16x32_bf16 v[28:31], v[208:211], v[60:63], v[28:31]
  s_add_u32 m0, s12, 102400
  s_mov_b32 s4, 0
  s_setprio 0
  buffer_load_dwordx4 v244, s[44:47], s4 offen lds
  s_setprio 1
  v_mfma_f32_16x16x32_bf16 v[32:35], v[212:215], v[60:63], v[32:35]
  v_mfma_f32_16x16x32_bf16 v[36:39], v[216:219], v[60:63], v[36:39]
  s_add_u32 m0, s12, 106496
  s_mov_b32 s4, 0
  s_setprio 0
  buffer_load_dwordx4 v245, s[44:47], s4 offen lds
  s_setprio 1
  v_mfma_f32_16x16x32_bf16 v[40:43], v[220:223], v[60:63], v[40:43]
  s_setprio 3
  v_add_u32 v249, 51200, v249
  v_add_u32 v250, 51200, v250
  v_add_u32 v251, 51200, v251
  v_add_u32 v252, 51200, v252
  v_add_u32 v253, 51200, v253
  s_setprio 1
  ds_read_b64_tr_b16 v[204:205], v249 offset:0
  ds_read_b64_tr_b16 v[206:207], v249 offset:1280
  ds_read_b64_tr_b16 v[208:209], v249 offset:32
  ds_read_b64_tr_b16 v[210:211], v249 offset:1312
  ds_read_b64_tr_b16 v[212:213], v249 offset:64
  ds_read_b64_tr_b16 v[214:215], v249 offset:1344
  ds_read_b64_tr_b16 v[216:217], v249 offset:96
  ds_read_b64_tr_b16 v[218:219], v249 offset:1376
  ds_read_b64_tr_b16 v[220:221], v249 offset:128
  ds_read_b64_tr_b16 v[222:223], v249 offset:1408
  v_mfma_f32_16x16x32_bf16 v[24:27], v[224:227], v[64:67], v[24:27]
  buffer_load_dwordx4 v[112:115], v254, s[48:51], s19 offen offset:2048 sc1
  s_add_u32 s19, s19, 4096
  v_mfma_f32_16x16x32_bf16 v[28:31], v[228:231], v[64:67], v[28:31]
  s_add_u32 m0, s12, 110592
  s_mov_b32 s4, 0
  s_setprio 0
  buffer_load_dwordx4 v246, s[44:47], s4 offen lds
  s_setprio 1
  v_mfma_f32_16x16x32_bf16 v[32:35], v[232:235], v[64:67], v[32:35]
  v_mfma_f32_16x16x32_bf16 v[36:39], v[236:239], v[64:67], v[36:39]
  s_add_u32 m0, s12, 114688
  s_mov_b32 s4, 0
  s_setprio 0
  buffer_load_dwordx4 v247, s[44:47], s4 offen lds
  s_setprio 1
  v_mfma_f32_16x16x32_bf16 v[40:43], v[240:243], v[64:67], v[40:43]
  ds_read_b64_tr_b16 v[224:225], v249 offset:6400
  ds_read_b64_tr_b16 v[226:227], v249 offset:7680
  ds_read_b64_tr_b16 v[228:229], v249 offset:6432
  ds_read_b64_tr_b16 v[230:231], v249 offset:7712
  ds_read_b64_tr_b16 v[232:233], v249 offset:6464
  ds_read_b64_tr_b16 v[234:235], v249 offset:7744
  ds_read_b64_tr_b16 v[236:237], v249 offset:6496
  ds_read_b64_tr_b16 v[238:239], v249 offset:7776
  ds_read_b64_tr_b16 v[240:241], v249 offset:6528
  ds_read_b64_tr_b16 v[242:243], v249 offset:7808
  s_waitcnt vmcnt(14)
F_hck6:
  s_setprio 3
  v_max3_u32 v4, v68, v69, v70
  v_max3_u32 v5, v71, v72, v73
  v_max3_u32 v4, v4, v74, v75
  v_max_u32 v4, v4, v5
  v_cmp_eq_u32 vcc, -1, v4
  s_setprio 1
  s_cbranch_vccnz F_hrt6

F_hgo6:
  v_mfma_f32_16x16x32_bf16 v[24:27], v[124:127], v[68:71], v[24:27]
  buffer_load_dwordx4 v[116:119], v254, s[48:51], s19 offen offset:0 sc1
  v_mfma_f32_16x16x32_bf16 v[28:31], v[128:131], v[68:71], v[28:31]
  s_add_u32 m0, s12, 118784
  s_mov_b32 s4, 0
  s_setprio 0
  buffer_load_dwordx4 v248, s[44:47], s4 offen lds
  s_setprio 1
  v_mfma_f32_16x16x32_bf16 v[32:35], v[132:135], v[68:71], v[32:35]
  v_mfma_f32_16x16x32_bf16 v[36:39], v[136:139], v[68:71], v[36:39]
  s_add_u32 m0, s12, 122880
  s_mov_b32 s4, 163840
  s_setprio 0
  buffer_load_dwordx4 v244, s[44:47], s4 offen lds
  s_setprio 1
  v_mfma_f32_16x16x32_bf16 v[40:43], v[140:143], v[68:71], v[40:43]
  ds_read_b64_tr_b16 v[124:125], v250 offset:0
  ds_read_b64_tr_b16 v[126:127], v251 offset:0
  ds_read_b64_tr_b16 v[128:129], v250 offset:32
  ds_read_b64_tr_b16 v[130:131], v251 offset:32
  ds_read_b64_tr_b16 v[132:133], v250 offset:64
  ds_read_b64_tr_b16 v[134:135], v251 offset:64
  ds_read_b64_tr_b16 v[136:137], v250 offset:96
  ds_read_b64_tr_b16 v[138:139], v251 offset:96
  ds_read_b64_tr_b16 v[140:141], v250 offset:128
  ds_read_b64_tr_b16 v[142:143], v251 offset:128
  v_mfma_f32_16x16x32_bf16 v[24:27], v[144:147], v[72:75], v[24:27]
  buffer_load_dwordx4 v[120:123], v254, s[48:51], s19 offen offset:2048 sc1
  s_add_u32 s19, s19, 4096
  v_mfma_f32_16x16x32_bf16 v[28:31], v[148:151], v[72:75], v[28:31]
  s_add_u32 m0, s12, 126976
  s_mov_b32 s4, 163840
  s_setprio 0
  buffer_load_dwordx4 v245, s[44:47], s4 offen lds
  s_setprio 1
  v_mfma_f32_16x16x32_bf16 v[32:35], v[152:155], v[72:75], v[32:35]
  v_mfma_f32_16x16x32_bf16 v[36:39], v[156:159], v[72:75], v[36:39]
  s_add_u32 m0, s12, 131072
  s_mov_b32 s4, 163840
  s_setprio 0
  buffer_load_dwordx4 v246, s[44:47], s4 offen lds
  s_setprio 1
  v_mfma_f32_16x16x32_bf16 v[40:43], v[160:163], v[72:75], v[40:43]
  ds_read_b64_tr_b16 v[144:145], v249 offset:16000
  ds_read_b64_tr_b16 v[146:147], v249 offset:17280
  ds_read_b64_tr_b16 v[148:149], v249 offset:16032
  ds_read_b64_tr_b16 v[150:151], v249 offset:17312
  ds_read_b64_tr_b16 v[152:153], v249 offset:16064
  ds_read_b64_tr_b16 v[154:155], v249 offset:17344
  ds_read_b64_tr_b16 v[156:157], v249 offset:16096
  ds_read_b64_tr_b16 v[158:159], v249 offset:17376
  ds_read_b64_tr_b16 v[160:161], v249 offset:16128
  ds_read_b64_tr_b16 v[162:163], v249 offset:17408
  s_waitcnt vmcnt(18) lgkmcnt(15)
F_hck8:
  s_setprio 3
  v_max3_u32 v4, v76, v77, v78
  v_max3_u32 v5, v79, v80, v81
  v_max3_u32 v4, v4, v82, v83
  v_max_u32 v4, v4, v5
  v_cmp_eq_u32 vcc, -1, v4
  s_setprio 1
  s_cbranch_vccnz F_hrt8

F_hgo8:
  v_mfma_f32_16x16x32_bf16 v[24:27], v[164:167], v[76:79], v[24:27]
  v_mfma_f32_16x16x32_bf16 v[28:31], v[168:171], v[76:79], v[28:31]
  s_add_u32 m0, s12, 135168
  s_mov_b32 s4, 163840
  s_setprio 0
  buffer_load_dwordx4 v247, s[44:47], s4 offen lds
  s_setprio 1
  v_mfma_f32_16x16x32_bf16 v[32:35], v[172:175], v[76:79], v[32:35]
  v_mfma_f32_16x16x32_bf16 v[36:39], v[176:179], v[76:79], v[36:39]
  s_add_u32 m0, s12, 139264
  s_mov_b32 s4, 163840
  s_setprio 0
  buffer_load_dwordx4 v248, s[44:47], s4 offen lds
  s_setprio 1
  v_mfma_f32_16x16x32_bf16 v[40:43], v[180:183], v[76:79], v[40:43]
  ds_read_b64_tr_b16 v[164:165], v252 offset:0
  ds_read_b64_tr_b16 v[166:167], v253 offset:0
  ds_read_b64_tr_b16 v[168:169], v252 offset:32
  ds_read_b64_tr_b16 v[170:171], v253 offset:32
  ds_read_b64_tr_b16 v[172:173], v252 offset:64
  ds_read_b64_tr_b16 v[174:175], v253 offset:64
  ds_read_b64_tr_b16 v[176:177], v252 offset:96
  ds_read_b64_tr_b16 v[178:179], v253 offset:96
  ds_read_b64_tr_b16 v[180:181], v252 offset:128
  ds_read_b64_tr_b16 v[182:183], v253 offset:128
  v_mfma_f32_16x16x32_bf16 v[24:27], v[184:187], v[80:83], v[24:27]
  v_mfma_f32_16x16x32_bf16 v[28:31], v[188:191], v[80:83], v[28:31]
  s_add_u32 m0, s12, 143360
  s_mov_b32 s4, 327680
  s_setprio 0
  buffer_load_dwordx4 v244, s[44:47], s4 offen lds
  s_setprio 1
  v_mfma_f32_16x16x32_bf16 v[32:35], v[192:195], v[80:83], v[32:35]
  v_mfma_f32_16x16x32_bf16 v[36:39], v[196:199], v[80:83], v[36:39]
  s_add_u32 m0, s12, 147456
  s_mov_b32 s4, 327680
  s_setprio 0
  buffer_load_dwordx4 v245, s[44:47], s4 offen lds
  s_setprio 1
  v_mfma_f32_16x16x32_bf16 v[40:43], v[200:203], v[80:83], v[40:43]
  ds_read_b64_tr_b16 v[184:185], v249 offset:25600
  ds_read_b64_tr_b16 v[186:187], v249 offset:26880
  ds_read_b64_tr_b16 v[188:189], v249 offset:25632
  ds_read_b64_tr_b16 v[190:191], v249 offset:26912
  ds_read_b64_tr_b16 v[192:193], v249 offset:25664
  ds_read_b64_tr_b16 v[194:195], v249 offset:26944
  ds_read_b64_tr_b16 v[196:197], v249 offset:25696
  ds_read_b64_tr_b16 v[198:199], v249 offset:26976
  ds_read_b64_tr_b16 v[200:201], v249 offset:25728
  ds_read_b64_tr_b16 v[202:203], v249 offset:27008
  s_mov_b64 exec, 1
  ds_add_u32 v8, v9 offset:76
  s_mov_b64 exec, -1
  s_waitcnt vmcnt(20)
F_hck10:
  s_setprio 3
  v_max3_u32 v4, v84, v85, v86
  v_max3_u32 v5, v87, v88, v89
  v_max3_u32 v4, v4, v90, v91
  v_max_u32 v4, v4, v5
  v_cmp_eq_u32 vcc, -1, v4
  s_setprio 1
  s_cbranch_vccnz F_hrt10

F_hgo10:
  v_mfma_f32_16x16x32_bf16 v[24:27], v[204:207], v[84:87], v[24:27]
  v_mfma_f32_16x16x32_bf16 v[28:31], v[208:211], v[84:87], v[28:31]
  s_add_u32 m0, s12, 151552
  s_mov_b32 s4, 327680
  s_setprio 0
  buffer_load_dwordx4 v246, s[44:47], s4 offen lds
  s_setprio 1
  v_mfma_f32_16x16x32_bf16 v[32:35], v[212:215], v[84:87], v[32:35]
  v_mfma_f32_16x16x32_bf16 v[36:39], v[216:219], v[84:87], v[36:39]
  v_mfma_f32_16x16x32_bf16 v[40:43], v[220:223], v[84:87], v[40:43]
  ds_read_b64_tr_b16 v[204:205], v249 offset:32000
  ds_read_b64_tr_b16 v[206:207], v249 offset:33280
  ds_read_b64_tr_b16 v[208:209], v249 offset:32032
  ds_read_b64_tr_b16 v[210:211], v249 offset:33312
  ds_read_b64_tr_b16 v[212:213], v249 offset:32064
  ds_read_b64_tr_b16 v[214:215], v249 offset:33344
  ds_read_b64_tr_b16 v[216:217], v249 offset:32096
  ds_read_b64_tr_b16 v[218:219], v249 offset:33376
  ds_read_b64_tr_b16 v[220:221], v249 offset:32128
  ds_read_b64_tr_b16 v[222:223], v249 offset:33408
  v_mfma_f32_16x16x32_bf16 v[24:27], v[224:227], v[88:91], v[24:27]
  v_mfma_f32_16x16x32_bf16 v[28:31], v[228:231], v[88:91], v[28:31]
  v_mfma_f32_16x16x32_bf16 v[32:35], v[232:235], v[88:91], v[32:35]
  v_mfma_f32_16x16x32_bf16 v[36:39], v[236:239], v[88:91], v[36:39]
  v_mfma_f32_16x16x32_bf16 v[40:43], v[240:243], v[88:91], v[40:43]
  s_waitcnt vmcnt(7)
F_hck12:
  s_setprio 3
  v_max3_u32 v4, v92, v93, v94
  v_max3_u32 v5, v95, v96, v97
  v_max3_u32 v4, v4, v98, v99
  v_max_u32 v4, v4, v5
  v_cmp_eq_u32 vcc, -1, v4
  s_setprio 1
  s_cbranch_vccnz F_hrt12

F_hgo12:
F_hck14:
  s_setprio 3
  v_max3_u32 v4, v100, v101, v102
  v_max3_u32 v5, v103, v104, v105
  v_max3_u32 v4, v4, v106, v107
  v_max_u32 v4, v4, v5
  v_cmp_eq_u32 vcc, -1, v4
  s_setprio 1
  s_cbranch_vccnz F_hrt14

F_hgo14:
F_hck16:
  s_setprio 3
  v_max3_u32 v4, v108, v109, v110
  v_max3_u32 v5, v111, v112, v113
  v_max3_u32 v4, v4, v114, v115
  v_max_u32 v4, v4, v5
  v_cmp_eq_u32 vcc, -1, v4
  s_setprio 1
  s_cbranch_vccnz F_hrt16

F_hgo16:
F_hck18:
  s_setprio 3
  v_max3_u32 v4, v116, v117, v118
  v_max3_u32 v5, v119, v120, v121
  v_max3_u32 v4, v4, v122, v123
  v_max_u32 v4, v4, v5
  v_cmp_eq_u32 vcc, -1, v4
  s_setprio 1
  s_cbranch_vccnz F_hrt18

F_hgo18:
  s_setprio 3
  v_mov_b32 v7, 161792
  s_mov_b32 s4, 0
F_l22:
  ds_read_b32 v6, v7 offset:76
  s_add_u32 s4, s4, 1
  s_waitcnt lgkmcnt(0)
  v_readfirstlane_b32 s3, v6
  s_cmp_ge_u32 s3, 4
  s_cbranch_scc1 F_l22_ok

  s_setprio 1
  s_cmp_lt_u32 s4, 1600000
  s_cbranch_scc1 F_l22

F_l22_ok:
  s_setprio 1
  ds_read_b64_tr_b16 v[224:225], v250 offset:25600
  ds_read_b64_tr_b16 v[226:227], v251 offset:25600
  ds_read_b64_tr_b16 v[228:229], v250 offset:25632
  ds_read_b64_tr_b16 v[230:231], v251 offset:25632
  ds_read_b64_tr_b16 v[232:233], v250 offset:25664
  ds_read_b64_tr_b16 v[234:235], v251 offset:25664
  ds_read_b64_tr_b16 v[236:237], v250 offset:25696
  ds_read_b64_tr_b16 v[238:239], v251 offset:25696
  ds_read_b64_tr_b16 v[240:241], v250 offset:25728
  ds_read_b64_tr_b16 v[242:243], v251 offset:25728
  v_mfma_f32_16x16x32_bf16 v[24:27], v[124:127], v[92:95], v[24:27]
  v_mfma_f32_16x16x32_bf16 v[28:31], v[128:131], v[92:95], v[28:31]
  s_add_u32 m0, s12, 0
  s_mov_b32 s4, 409600
  s_setprio 0
  buffer_load_dwordx4 v244, s[44:47], s4 offen lds
  s_setprio 1
  v_mfma_f32_16x16x32_bf16 v[32:35], v[132:135], v[92:95], v[32:35]
  v_mfma_f32_16x16x32_bf16 v[36:39], v[136:139], v[92:95], v[36:39]
  s_add_u32 m0, s12, 4096
  s_mov_b32 s4, 409600
  s_setprio 0
  buffer_load_dwordx4 v245, s[44:47], s4 offen lds
  s_setprio 1
  v_mfma_f32_16x16x32_bf16 v[40:43], v[140:143], v[92:95], v[40:43]
  ds_read_b64_tr_b16 v[124:125], v249 offset:41600
  ds_read_b64_tr_b16 v[126:127], v249 offset:42880
  ds_read_b64_tr_b16 v[128:129], v249 offset:41632
  ds_read_b64_tr_b16 v[130:131], v249 offset:42912
  ds_read_b64_tr_b16 v[132:133], v249 offset:41664
  ds_read_b64_tr_b16 v[134:135], v249 offset:42944
  ds_read_b64_tr_b16 v[136:137], v249 offset:41696
  ds_read_b64_tr_b16 v[138:139], v249 offset:42976
  ds_read_b64_tr_b16 v[140:141], v249 offset:41728
  ds_read_b64_tr_b16 v[142:143], v249 offset:43008
  v_mfma_f32_16x16x32_bf16 v[24:27], v[144:147], v[96:99], v[24:27]
  v_mfma_f32_16x16x32_bf16 v[28:31], v[148:151], v[96:99], v[28:31]
  s_add_u32 m0, s12, 8192
  s_mov_b32 s4, 409600
  s_setprio 0
  buffer_load_dwordx4 v246, s[44:47], s4 offen lds
  s_setprio 1
  v_mfma_f32_16x16x32_bf16 v[32:35], v[152:155], v[96:99], v[32:35]
  v_mfma_f32_16x16x32_bf16 v[36:39], v[156:159], v[96:99], v[36:39]
  s_add_u32 m0, s12, 12288
  s_mov_b32 s4, 409600
  s_setprio 0
  buffer_load_dwordx4 v247, s[44:47], s4 offen lds
  s_setprio 1
  v_mfma_f32_16x16x32_bf16 v[40:43], v[160:163], v[96:99], v[40:43]
  ds_read_b64_tr_b16 v[144:145], v252 offset:25600
  ds_read_b64_tr_b16 v[146:147], v253 offset:25600
  ds_read_b64_tr_b16 v[148:149], v252 offset:25632
  ds_read_b64_tr_b16 v[150:151], v253 offset:25632
  ds_read_b64_tr_b16 v[152:153], v252 offset:25664
  ds_read_b64_tr_b16 v[154:155], v253 offset:25664
  ds_read_b64_tr_b16 v[156:157], v252 offset:25696
  ds_read_b64_tr_b16 v[158:159], v253 offset:25696
  ds_read_b64_tr_b16 v[160:161], v252 offset:25728
  ds_read_b64_tr_b16 v[162:163], v253 offset:25728
  v_mfma_f32_16x16x32_bf16 v[24:27], v[164:167], v[100:103], v[24:27]
  v_mfma_f32_16x16x32_bf16 v[28:31], v[168:171], v[100:103], v[28:31]
  s_add_u32 m0, s12, 16384
  s_mov_b32 s4, 409600
  s_setprio 0
  buffer_load_dwordx4 v248, s[44:47], s4 offen lds
  s_setprio 1
  v_mfma_f32_16x16x32_bf16 v[32:35], v[172:175], v[100:103], v[32:35]
  v_mfma_f32_16x16x32_bf16 v[36:39], v[176:179], v[100:103], v[36:39]
  s_add_u32 m0, s12, 20480
  s_mov_b32 s4, 573440
  s_setprio 0
  buffer_load_dwordx4 v244, s[44:47], s4 offen lds
  s_setprio 1
  v_mfma_f32_16x16x32_bf16 v[40:43], v[180:183], v[100:103], v[40:43]
  s_waitcnt vmcnt(6)
  s_mov_b64 exec, 1
  ds_add_u32 v8, v9 offset:112
  s_mov_b64 exec, -1
  v_mfma_f32_16x16x32_bf16 v[24:27], v[184:187], v[104:107], v[24:27]
  v_mfma_f32_16x16x32_bf16 v[28:31], v[188:191], v[104:107], v[28:31]
  s_add_u32 m0, s12, 24576
  s_mov_b32 s4, 573440
  s_setprio 0
  buffer_load_dwordx4 v245, s[44:47], s4 offen lds
  s_setprio 1
  v_mfma_f32_16x16x32_bf16 v[32:35], v[192:195], v[104:107], v[32:35]
  v_mfma_f32_16x16x32_bf16 v[36:39], v[196:199], v[104:107], v[36:39]
  s_add_u32 m0, s12, 28672
  s_mov_b32 s4, 573440
  s_setprio 0
  buffer_load_dwordx4 v246, s[44:47], s4 offen lds
  s_setprio 1
  v_mfma_f32_16x16x32_bf16 v[40:43], v[200:203], v[104:107], v[40:43]
  v_mfma_f32_16x16x32_bf16 v[24:27], v[204:207], v[108:111], v[24:27]
  v_mfma_f32_16x16x32_bf16 v[28:31], v[208:211], v[108:111], v[28:31]
  s_add_u32 m0, s12, 32768
  s_mov_b32 s4, 573440
  s_setprio 0
  buffer_load_dwordx4 v247, s[44:47], s4 offen lds
  s_setprio 1
  v_mfma_f32_16x16x32_bf16 v[32:35], v[212:215], v[108:111], v[32:35]
  v_mfma_f32_16x16x32_bf16 v[36:39], v[216:219], v[108:111], v[36:39]
  s_add_u32 m0, s12, 36864
  s_mov_b32 s4, 573440
  s_setprio 0
  buffer_load_dwordx4 v248, s[44:47], s4 offen lds
  s_setprio 1
  v_mfma_f32_16x16x32_bf16 v[40:43], v[220:223], v[108:111], v[40:43]
  s_waitcnt lgkmcnt(15)
  v_mfma_f32_16x16x32_bf16 v[24:27], v[224:227], v[112:115], v[24:27]
  v_mfma_f32_16x16x32_bf16 v[28:31], v[228:231], v[112:115], v[28:31]
  s_add_u32 m0, s12, 40960
  s_mov_b32 s4, 737280
  s_setprio 0
  buffer_load_dwordx4 v244, s[44:47], s4 offen lds
  s_setprio 1
  v_mfma_f32_16x16x32_bf16 v[32:35], v[232:235], v[112:115], v[32:35]
  v_mfma_f32_16x16x32_bf16 v[36:39], v[236:239], v[112:115], v[36:39]
  s_add_u32 m0, s12, 45056
  s_mov_b32 s4, 737280
  s_setprio 0
  buffer_load_dwordx4 v245, s[44:47], s4 offen lds
  s_setprio 1
  v_mfma_f32_16x16x32_bf16 v[40:43], v[240:243], v[112:115], v[40:43]
  s_waitcnt lgkmcnt(0)
  v_mfma_f32_16x16x32_bf16 v[24:27], v[124:127], v[116:119], v[24:27]
  v_mfma_f32_16x16x32_bf16 v[28:31], v[128:131], v[116:119], v[28:31]
  s_add_u32 m0, s12, 49152
  s_mov_b32 s4, 737280
  s_cmp_ge_u32 s10, 2
  s_cbranch_scc1 F_nodma
  s_setprio 0
  buffer_load_dwordx4 v246, s[44:47], s4 offen lds
  s_setprio 1
F_nodma:
  v_mfma_f32_16x16x32_bf16 v[32:35], v[132:135], v[116:119], v[32:35]
  v_mfma_f32_16x16x32_bf16 v[36:39], v[136:139], v[116:119], v[36:39]
  v_mfma_f32_16x16x32_bf16 v[40:43], v[140:143], v[116:119], v[40:43]
  v_mfma_f32_16x16x32_bf16 v[24:27], v[144:147], v[120:123], v[24:27]
  v_mfma_f32_16x16x32_bf16 v[28:31], v[148:151], v[120:123], v[28:31]
  v_mfma_f32_16x16x32_bf16 v[32:35], v[152:155], v[120:123], v[32:35]
  v_mfma_f32_16x16x32_bf16 v[36:39], v[156:159], v[120:123], v[36:39]
  v_mfma_f32_16x16x32_bf16 v[40:43], v[160:163], v[120:123], v[40:43]
  s_setprio 3
  v_subrev_u32 v249, 51200, v249
  v_subrev_u32 v250, 51200, v250
  v_subrev_u32 v251, 51200, v251
  v_subrev_u32 v252, 51200, v252
  v_subrev_u32 v253, 51200, v253
  s_add_u32 s22, s21, 20480
  s_waitcnt vmcnt(0)
  v_mov_b32 v4, 161792
  v_mov_b32 v5, 1
  s_mov_b64 exec, 1
  ds_add_u32 v4, v5 offset:36
  s_mov_b64 exec, -1

  s_setprio 0
  v_mov_b32 v7, 161792
  s_mov_b32 s4, 0
F_l23:
  ds_read_b32 v6, v7 offset:36
  s_add_u32 s4, s4, 1
  s_waitcnt lgkmcnt(0)
  v_readfirstlane_b32 s3, v6
  s_cmp_ge_u32 s3, 16
  s_cbranch_scc1 F_l23_ok

  s_sleep 1
  s_cmp_lt_u32 s4, 1600000
  s_cbranch_scc1 F_l23

F_l23_ok:
  s_call_b64 s[98:99], F_wpre
  v_mov_b32 v7, 161792
  s_mov_b32 s4, 0
F_l24:
  ds_read_b32 v6, v7 offset:72
  s_add_u32 s4, s4, 1
  s_waitcnt lgkmcnt(0)
  v_readfirstlane_b32 s3, v6
  s_cmp_ge_u32 s3, 4
  s_cbranch_scc1 F_l24_ok

  s_sleep 1
  s_cmp_lt_u32 s4, 1600000
  s_cbranch_scc1 F_l24

F_l24_ok:
F_phaseC0:
  s_add_u32 s23, s22, 4096
  s_add_u32 s26, s22, 8192
  s_add_u32 s27, s22, 12288
  s_add_u32 s28, s22, 16384
  s_mov_b32 s19, 0

  s_call_b64 s[98:99], F_cl0
F_phaseC1:
  s_mov_b32 s52, s34
  s_mov_b32 s53, s35
  s_mov_b32 s54, 2621440
  s_mov_b32 s55, 0x20000
  s_and_b32 s5, s9, 3
  s_mul_i32 s3, s5, 6144
  s_add_u32 s3, s3, 51200
  v_lshlrev_b32 v12, 4, v1
  v_add_u32 v12, s3, v12
  s_lshl_b32 s3, s5, 2
  s_add_u32 s3, s3, 161872
  v_mov_b32 v13, s3
  v_mul_u32_u24 v14, 1280, v10
  v_and_b32 v16, 1, v11
  v_lshl_add_u32 v16, v16, 5, v14
  v_lshl_add_u32 v16, v2, 4, v16
  v_lshl_add_u32 v14, v11, 3, v14
  s_lshl_b32 s3, s7, 6
  s_lshl_b32 s4, s5, 4
  s_add_u32 s3, s3, s4
  s_mul_i32 s13, s3, 1280
  s_mul_i32 s5, s8, 160
  s_add_u32 s13, s13, s5
  v_mov_b32 v15, 1

  s_waitcnt lgkmcnt(0)
F_ck0:
  s_waitcnt vmcnt(8)
  v_max3_u32 v4, v44, v45, v46
  v_max3_u32 v5, v47, v48, v49
  v_max3_u32 v4, v4, v50, v51
  v_max_u32 v4, v4, v5
  v_cmp_eq_u32 vcc, -1, v4
  s_cbranch_vccnz F_rt0

F_go0:
  v_mfma_f32_16x16x32_bf16 v[24:27], v[84:87], v[44:47], v[24:27]
  v_mfma_f32_16x16x32_bf16 v[28:31], v[88:91], v[44:47], v[28:31]
  v_mfma_f32_16x16x32_bf16 v[32:35], v[92:95], v[44:47], v[32:35]
  v_mfma_f32_16x16x32_bf16 v[36:39], v[96:99], v[44:47], v[36:39]
  v_mfma_f32_16x16x32_bf16 v[40:43], v[100:103], v[44:47], v[40:43]
  v_mfma_f32_16x16x32_bf16 v[24:27], v[104:107], v[48:51], v[24:27]
  v_mfma_f32_16x16x32_bf16 v[28:31], v[108:111], v[48:51], v[28:31]
  v_mfma_f32_16x16x32_bf16 v[32:35], v[112:115], v[48:51], v[32:35]
  v_mfma_f32_16x16x32_bf16 v[36:39], v[116:119], v[48:51], v[36:39]
  v_mfma_f32_16x16x32_bf16 v[40:43], v[120:123], v[48:51], v[40:43]
  ds_read_b64_tr_b16 v[84:85], v249 offset:41600
  ds_read_b64_tr_b16 v[86:87], v249 offset:42880
  ds_read_b64_tr_b16 v[88:89], v249 offset:41632
  ds_read_b64_tr_b16 v[90:91], v249 offset:42912
  ds_read_b64_tr_b16 v[92:93], v249 offset:41664
  ds_read_b64_tr_b16 v[94:95], v249 offset:42944
  ds_read_b64_tr_b16 v[96:97], v249 offset:41696
  ds_read_b64_tr_b16 v[98:99], v249 offset:42976
  ds_read_b64_tr_b16 v[100:101], v249 offset:41728
  ds_read_b64_tr_b16 v[102:103], v249 offset:43008
F_ck2:
  s_waitcnt vmcnt(6)
  v_max3_u32 v4, v52, v53, v54
  v_max3_u32 v5, v55, v56, v57
  v_max3_u32 v4, v4, v58, v59
  v_max_u32 v4, v4, v5
  v_cmp_eq_u32 vcc, -1, v4
  s_cbranch_vccnz F_rt2

F_go2:
  v_mfma_f32_16x16x32_bf16 v[24:27], v[124:127], v[52:55], v[24:27]
  v_mfma_f32_16x16x32_bf16 v[28:31], v[128:131], v[52:55], v[28:31]
  v_mfma_f32_16x16x32_bf16 v[32:35], v[132:135], v[52:55], v[32:35]
  v_mfma_f32_16x16x32_bf16 v[36:39], v[136:139], v[52:55], v[36:39]
  v_mfma_f32_16x16x32_bf16 v[40:43], v[140:143], v[52:55], v[40:43]
  ds_read_b64_tr_b16 v[104:105], v252 offset:25600
  ds_read_b64_tr_b16 v[106:107], v253 offset:25600
  ds_read_b64_tr_b16 v[108:109], v252 offset:25632
  ds_read_b64_tr_b16 v[110:111], v253 offset:25632
  ds_read_b64_tr_b16 v[112:113], v252 offset:25664
  ds_read_b64_tr_b16 v[114:115], v253 offset:25664
  ds_read_b64_tr_b16 v[116:117], v252 offset:25696
  ds_read_b64_tr_b16 v[118:119], v253 offset:25696
  ds_read_b64_tr_b16 v[120:121], v252 offset:25728
  ds_read_b64_tr_b16 v[122:123], v253 offset:25728
  v_mfma_f32_16x16x32_bf16 v[24:27], v[144:147], v[56:59], v[24:27]
  v_mfma_f32_16x16x32_bf16 v[28:31], v[148:151], v[56:59], v[28:31]
  v_mfma_f32_16x16x32_bf16 v[32:35], v[152:155], v[56:59], v[32:35]
  v_mfma_f32_16x16x32_bf16 v[36:39], v[156:159], v[56:59], v[36:39]
  v_mfma_f32_16x16x32_bf16 v[40:43], v[160:163], v[56:59], v[40:43]
F_ck4:
  s_waitcnt vmcnt(4)
  v_max3_u32 v4, v60, v61, v62
  v_max3_u32 v5, v63, v64, v65
  v_max3_u32 v4, v4, v66, v67
  v_max_u32 v4, v4, v5
  v_cmp_eq_u32 vcc, -1, v4
  s_cbranch_vccnz F_rt4

F_go4:
  v_mfma_f32_16x16x32_bf16 v[24:27], v[164:167], v[60:63], v[24:27]
  v_mfma_f32_16x16x32_bf16 v[28:31], v[168:171], v[60:63], v[28:31]
  v_mfma_f32_16x16x32_bf16 v[32:35], v[172:175], v[60:63], v[32:35]
  v_mfma_f32_16x16x32_bf16 v[36:39], v[176:179], v[60:63], v[36:39]
  v_mfma_f32_16x16x32_bf16 v[40:43], v[180:183], v[60:63], v[40:43]
  v_mfma_f32_16x16x32_bf16 v[24:27], v[184:187], v[64:67], v[24:27]
  v_mfma_f32_16x16x32_bf16 v[28:31], v[188:191], v[64:67], v[28:31]
  v_mfma_f32_16x16x32_bf16 v[32:35], v[192:195], v[64:67], v[32:35]
  v_mfma_f32_16x16x32_bf16 v[36:39], v[196:199], v[64:67], v[36:39]
  v_mfma_f32_16x16x32_bf16 v[40:43], v[200:203], v[64:67], v[40:43]
F_ck6:
  s_waitcnt vmcnt(2)
  v_max3_u32 v4, v68, v69, v70
  v_max3_u32 v5, v71, v72, v73
  v_max3_u32 v4, v4, v74, v75
  v_max_u32 v4, v4, v5
  v_cmp_eq_u32 vcc, -1, v4
  s_cbranch_vccnz F_rt6

F_go6:
  v_mfma_f32_16x16x32_bf16 v[24:27], v[204:207], v[68:71], v[24:27]
  v_mfma_f32_16x16x32_bf16 v[28:31], v[208:211], v[68:71], v[28:31]
  v_mfma_f32_16x16x32_bf16 v[32:35], v[212:215], v[68:71], v[32:35]
  v_mfma_f32_16x16x32_bf16 v[36:39], v[216:219], v[68:71], v[36:39]
  v_mfma_f32_16x16x32_bf16 v[40:43], v[220:223], v[68:71], v[40:43]
  v_mfma_f32_16x16x32_bf16 v[24:27], v[224:227], v[72:75], v[24:27]
  v_mfma_f32_16x16x32_bf16 v[28:31], v[228:231], v[72:75], v[28:31]
  v_mfma_f32_16x16x32_bf16 v[32:35], v[232:235], v[72:75], v[32:35]
  v_mfma_f32_16x16x32_bf16 v[36:39], v[236:239], v[72:75], v[36:39]
  v_mfma_f32_16x16x32_bf16 v[40:43], v[240:243], v[72:75], v[40:43]
  s_waitcnt lgkmcnt(10)
F_ck8:
  s_waitcnt vmcnt(0)
  v_max3_u32 v4, v76, v77, v78
  v_max3_u32 v5, v79, v80, v81
  v_max3_u32 v4, v4, v82, v83
  v_max_u32 v4, v4, v5
  v_cmp_eq_u32 vcc, -1, v4
  s_cbranch_vccnz F_rt8

F_go8:
  v_mfma_f32_16x16x32_bf16 v[24:27], v[84:87], v[76:79], v[24:27]
  v_mfma_f32_16x16x32_bf16 v[28:31], v[88:91], v[76:79], v[28:31]
  v_mfma_f32_16x16x32_bf16 v[32:35], v[92:95], v[76:79], v[32:35]
  v_mfma_f32_16x16x32_bf16 v[36:39], v[96:99], v[76:79], v[36:39]
  v_mfma_f32_16x16x32_bf16 v[40:43], v[100:103], v[76:79], v[40:43]
  s_waitcnt lgkmcnt(0)
  v_mfma_f32_16x16x32_bf16 v[24:27], v[104:107], v[80:83], v[24:27]
  v_mfma_f32_16x16x32_bf16 v[28:31], v[108:111], v[80:83], v[28:31]
  v_mfma_f32_16x16x32_bf16 v[32:35], v[112:115], v[80:83], v[32:35]
  v_mfma_f32_16x16x32_bf16 v[36:39], v[116:119], v[80:83], v[36:39]
  v_mfma_f32_16x16x32_bf16 v[40:43], v[120:123], v[80:83], v[40:43]
  s_cmp_ge_u32 s9, 4
  s_cbranch_scc1 F_red
  s_nop 3

  ds_write_b128 v12, v[24:27] offset:0
  ds_write_b128 v12, v[28:31] offset:1024
  ds_write_b128 v12, v[32:35] offset:2048
  ds_write_b128 v12, v[36:39] offset:3072
  ds_write_b128 v12, v[40:43] offset:4096
  s_waitcnt lgkmcnt(0)
  ds_write_b32 v13, v15
  s_waitcnt lgkmcnt(0)
  s_branch F_fin

F_red:
  s_mov_b32 s4, 0
F_red1:
  ds_read_b32 v4, v13
  ds_read_b128 v[44:47], v12 offset:0
  ds_read_b128 v[48:51], v12 offset:1024
  ds_read_b128 v[52:55], v12 offset:2048
  ds_read_b128 v[56:59], v12 offset:3072
  ds_read_b128 v[60:63], v12 offset:4096
  s_add_u32 s4, s4, 1
  s_waitcnt lgkmcnt(5)
  v_readfirstlane_b32 s3, v4
  s_cmp_lg_u32 s3, 0
  s_cbranch_scc1 F_red2
  s_cmp_lt_u32 s4, 1600000
  s_cbranch_scc1 F_red1

F_red2:
  s_waitcnt lgkmcnt(4)
  v_pk_add_f32 v[24:25], v[24:25], v[44:45]
  v_pk_add_f32 v[26:27], v[26:27], v[46:47]
  v_cvt_pk_bf16_f32 v24, v24, v25
  v_cvt_pk_bf16_f32 v25, v26, v27
  s_waitcnt lgkmcnt(3)
  v_pk_add_f32 v[28:29], v[28:29], v[48:49]
  v_pk_add_f32 v[30:31], v[30:31], v[50:51]
  v_cvt_pk_bf16_f32 v26, v28, v29
  v_cvt_pk_bf16_f32 v27, v30, v31
  s_waitcnt lgkmcnt(2)
  v_pk_add_f32 v[32:33], v[32:33], v[52:53]
  v_pk_add_f32 v[34:35], v[34:35], v[54:55]
  v_cvt_pk_bf16_f32 v32, v32, v33
  v_cvt_pk_bf16_f32 v33, v34, v35
  v_permlane16_swap_b32 v24, v26
  v_permlane16_swap_b32 v25, v27
  buffer_store_dwordx4 v[24:27], v16, s[52:55], s13 offen offset:0
  s_waitcnt lgkmcnt(1)
  v_pk_add_f32 v[36:37], v[36:37], v[56:57]
  v_pk_add_f32 v[38:39], v[38:39], v[58:59]
  v_cvt_pk_bf16_f32 v34, v36, v37
  v_cvt_pk_bf16_f32 v35, v38, v39
  s_waitcnt lgkmcnt(0)
  v_pk_add_f32 v[40:41], v[40:41], v[60:61]
  v_pk_add_f32 v[42:43], v[42:43], v[62:63]
  v_cvt_pk_bf16_f32 v40, v40, v41
  v_cvt_pk_bf16_f32 v41, v42, v43
  buffer_store_dwordx2 v[40:41], v14, s[52:55], s13 offen offset:128
  v_permlane16_swap_b32 v32, v34
  v_permlane16_swap_b32 v33, v35
  buffer_store_dwordx4 v[32:35], v16, s[52:55], s13 offen offset:64
F_fin:
F_end:
  s_endpgm
F_rt0:
  s_add_u32 s19, s19, 1
  s_cmp_gt_u32 s19, 200000
  s_cbranch_scc1 F_go0

  buffer_load_dwordx4 v[44:47], v254, s[48:51], s22 offen offset:0 sc1
  buffer_load_dwordx4 v[48:51], v254, s[48:51], s22 offen offset:2048 sc1
  buffer_load_dwordx4 v[52:55], v254, s[48:51], s23 offen offset:0 sc1
  buffer_load_dwordx4 v[56:59], v254, s[48:51], s23 offen offset:2048 sc1
  s_waitcnt vmcnt(0)
  s_branch F_ck0
F_rt2:
  s_add_u32 s19, s19, 1
  s_cmp_gt_u32 s19, 200000
  s_cbranch_scc1 F_go2

  buffer_load_dwordx4 v[52:55], v254, s[48:51], s23 offen offset:0 sc1
  buffer_load_dwordx4 v[56:59], v254, s[48:51], s23 offen offset:2048 sc1
  buffer_load_dwordx4 v[60:63], v254, s[48:51], s26 offen offset:0 sc1
  buffer_load_dwordx4 v[64:67], v254, s[48:51], s26 offen offset:2048 sc1
  s_waitcnt vmcnt(0)
  s_branch F_ck2
F_rt4:
  s_add_u32 s19, s19, 1
  s_cmp_gt_u32 s19, 200000
  s_cbranch_scc1 F_go4

  buffer_load_dwordx4 v[60:63], v254, s[48:51], s26 offen offset:0 sc1
  buffer_load_dwordx4 v[64:67], v254, s[48:51], s26 offen offset:2048 sc1
  buffer_load_dwordx4 v[68:71], v254, s[48:51], s27 offen offset:0 sc1
  buffer_load_dwordx4 v[72:75], v254, s[48:51], s27 offen offset:2048 sc1
  s_waitcnt vmcnt(0)
  s_branch F_ck4
F_rt6:
  s_add_u32 s19, s19, 1
  s_cmp_gt_u32 s19, 200000
  s_cbranch_scc1 F_go6

  buffer_load_dwordx4 v[68:71], v254, s[48:51], s27 offen offset:0 sc1
  buffer_load_dwordx4 v[72:75], v254, s[48:51], s27 offen offset:2048 sc1
  buffer_load_dwordx4 v[76:79], v254, s[48:51], s28 offen offset:0 sc1
  buffer_load_dwordx4 v[80:83], v254, s[48:51], s28 offen offset:2048 sc1
  s_waitcnt vmcnt(0)
  s_branch F_ck6
F_rt8:
  s_add_u32 s19, s19, 1
  s_cmp_gt_u32 s19, 200000
  s_cbranch_scc1 F_go8

  buffer_load_dwordx4 v[76:79], v254, s[48:51], s28 offen offset:0 sc1
  buffer_load_dwordx4 v[80:83], v254, s[48:51], s28 offen offset:2048 sc1
  s_waitcnt vmcnt(0)
  s_branch F_ck8
F_hrt0:
  s_add_u32 s18, s18, 1
  s_cmp_gt_u32 s18, 200000
  s_cbranch_scc1 F_hgo0
  s_add_u32 s3, s21, 40960
  s_add_u32 s4, s3, 4096

  buffer_load_dwordx4 v[44:47], v254, s[48:51], s3 offen offset:0 sc1
  buffer_load_dwordx4 v[48:51], v254, s[48:51], s3 offen offset:2048 sc1
  buffer_load_dwordx4 v[52:55], v254, s[48:51], s4 offen offset:0 sc1
  buffer_load_dwordx4 v[56:59], v254, s[48:51], s4 offen offset:2048 sc1
  s_waitcnt vmcnt(0)
  s_branch F_hck0
F_hrt2:
  s_add_u32 s18, s18, 1
  s_cmp_gt_u32 s18, 200000
  s_cbranch_scc1 F_hgo2
  s_add_u32 s3, s21, 45056
  s_add_u32 s4, s3, 4096

  buffer_load_dwordx4 v[52:55], v254, s[48:51], s3 offen offset:0 sc1
  buffer_load_dwordx4 v[56:59], v254, s[48:51], s3 offen offset:2048 sc1
  buffer_load_dwordx4 v[60:63], v254, s[48:51], s4 offen offset:0 sc1
  buffer_load_dwordx4 v[64:67], v254, s[48:51], s4 offen offset:2048 sc1
  s_waitcnt vmcnt(0)
  s_branch F_hck2
F_hrt4:
  s_add_u32 s18, s18, 1
  s_cmp_gt_u32 s18, 200000
  s_cbranch_scc1 F_hgo4
  s_add_u32 s3, s21, 49152
  s_add_u32 s4, s3, 4096

  buffer_load_dwordx4 v[60:63], v254, s[48:51], s3 offen offset:0 sc1
  buffer_load_dwordx4 v[64:67], v254, s[48:51], s3 offen offset:2048 sc1
  buffer_load_dwordx4 v[68:71], v254, s[48:51], s4 offen offset:0 sc1
  buffer_load_dwordx4 v[72:75], v254, s[48:51], s4 offen offset:2048 sc1
  s_waitcnt vmcnt(0)
  s_branch F_hck4
F_hrt6:
  s_add_u32 s18, s18, 1
  s_cmp_gt_u32 s18, 200000
  s_cbranch_scc1 F_hgo6
  s_add_u32 s3, s21, 53248
  s_add_u32 s4, s3, 4096

  buffer_load_dwordx4 v[68:71], v254, s[48:51], s3 offen offset:0 sc1
  buffer_load_dwordx4 v[72:75], v254, s[48:51], s3 offen offset:2048 sc1
  buffer_load_dwordx4 v[76:79], v254, s[48:51], s4 offen offset:0 sc1
  buffer_load_dwordx4 v[80:83], v254, s[48:51], s4 offen offset:2048 sc1
  s_waitcnt vmcnt(0)
  s_branch F_hck6
F_hrt8:
  s_add_u32 s18, s18, 1
  s_cmp_gt_u32 s18, 200000
  s_cbranch_scc1 F_hgo8
  s_add_u32 s3, s21, 57344
  s_add_u32 s4, s3, 4096

  buffer_load_dwordx4 v[76:79], v254, s[48:51], s3 offen offset:0 sc1
  buffer_load_dwordx4 v[80:83], v254, s[48:51], s3 offen offset:2048 sc1
  buffer_load_dwordx4 v[84:87], v254, s[48:51], s4 offen offset:0 sc1
  buffer_load_dwordx4 v[88:91], v254, s[48:51], s4 offen offset:2048 sc1
  s_waitcnt vmcnt(0)
  s_branch F_hck8
F_hrt10:
  s_add_u32 s18, s18, 1
  s_cmp_gt_u32 s18, 200000
  s_cbranch_scc1 F_hgo10
  s_add_u32 s3, s21, 61440
  s_add_u32 s4, s3, 4096

  buffer_load_dwordx4 v[84:87], v254, s[48:51], s3 offen offset:0 sc1
  buffer_load_dwordx4 v[88:91], v254, s[48:51], s3 offen offset:2048 sc1
  buffer_load_dwordx4 v[92:95], v254, s[48:51], s4 offen offset:0 sc1
  buffer_load_dwordx4 v[96:99], v254, s[48:51], s4 offen offset:2048 sc1
  s_waitcnt vmcnt(0)
  s_branch F_hck10
F_hrt12:
  s_add_u32 s18, s18, 1
  s_cmp_gt_u32 s18, 200000
  s_cbranch_scc1 F_hgo12
  s_add_u32 s3, s21, 65536
  s_add_u32 s4, s3, 4096

  buffer_load_dwordx4 v[92:95], v254, s[48:51], s3 offen offset:0 sc1
  buffer_load_dwordx4 v[96:99], v254, s[48:51], s3 offen offset:2048 sc1
  buffer_load_dwordx4 v[100:103], v254, s[48:51], s4 offen offset:0 sc1
  buffer_load_dwordx4 v[104:107], v254, s[48:51], s4 offen offset:2048 sc1
  s_waitcnt vmcnt(0)
  s_branch F_hck12
F_hrt14:
  s_add_u32 s18, s18, 1
  s_cmp_gt_u32 s18, 200000
  s_cbranch_scc1 F_hgo14
  s_add_u32 s3, s21, 69632
  s_add_u32 s4, s3, 4096

  buffer_load_dwordx4 v[100:103], v254, s[48:51], s3 offen offset:0 sc1
  buffer_load_dwordx4 v[104:107], v254, s[48:51], s3 offen offset:2048 sc1
  buffer_load_dwordx4 v[108:111], v254, s[48:51], s4 offen offset:0 sc1
  buffer_load_dwordx4 v[112:115], v254, s[48:51], s4 offen offset:2048 sc1
  s_waitcnt vmcnt(0)
  s_branch F_hck14
F_hrt16:
  s_add_u32 s18, s18, 1
  s_cmp_gt_u32 s18, 200000
  s_cbranch_scc1 F_hgo16
  s_add_u32 s3, s21, 73728
  s_add_u32 s4, s3, 4096

  buffer_load_dwordx4 v[108:111], v254, s[48:51], s3 offen offset:0 sc1
  buffer_load_dwordx4 v[112:115], v254, s[48:51], s3 offen offset:2048 sc1
  buffer_load_dwordx4 v[116:119], v254, s[48:51], s4 offen offset:0 sc1
  buffer_load_dwordx4 v[120:123], v254, s[48:51], s4 offen offset:2048 sc1
  s_waitcnt vmcnt(0)
  s_branch F_hck16
F_hrt18:
  s_add_u32 s18, s18, 1
  s_cmp_gt_u32 s18, 200000
  s_cbranch_scc1 F_hgo18
  s_add_u32 s3, s21, 77824
  s_add_u32 s4, s3, 4096

  buffer_load_dwordx4 v[116:119], v254, s[48:51], s3 offen offset:0 sc1
  buffer_load_dwordx4 v[120:123], v254, s[48:51], s3 offen offset:2048 sc1
  s_waitcnt vmcnt(0)
  s_branch F_hck18
F_cl0:
  buffer_load_dwordx4 v[44:47], v254, s[48:51], s22 offen offset:0 sc1
F_cl1:
  buffer_load_dwordx4 v[48:51], v254, s[48:51], s22 offen offset:2048 sc1
F_cl2:
  buffer_load_dwordx4 v[52:55], v254, s[48:51], s23 offen offset:0 sc1
F_cl3:
  buffer_load_dwordx4 v[56:59], v254, s[48:51], s23 offen offset:2048 sc1
F_cl4:
  buffer_load_dwordx4 v[60:63], v254, s[48:51], s26 offen offset:0 sc1
F_cl5:
  buffer_load_dwordx4 v[64:67], v254, s[48:51], s26 offen offset:2048 sc1
F_cl6:
  buffer_load_dwordx4 v[68:71], v254, s[48:51], s27 offen offset:0 sc1
F_cl7:
  buffer_load_dwordx4 v[72:75], v254, s[48:51], s27 offen offset:2048 sc1
F_cl8:
  buffer_load_dwordx4 v[76:79], v254, s[48:51], s28 offen offset:0 sc1
F_cl9:
  buffer_load_dwordx4 v[80:83], v254, s[48:51], s28 offen offset:2048 sc1
  s_setpc_b64 s[98:99]
F_last:
.section .rodata,"a"
.p2align 6
.amdhsa_kernel gated_mix__grouped_kv_mqa__sliding_local_dilated__prompt_kernel
  .amdhsa_next_free_vgpr 256
  .amdhsa_next_free_sgpr 102
  .amdhsa_accum_offset 256
  .amdhsa_group_segment_fixed_size 0
  .amdhsa_kernarg_size 96
  .amdhsa_user_sgpr_count 2
  .amdhsa_user_sgpr_kernarg_segment_ptr 1
  .amdhsa_system_sgpr_workgroup_id_x 1
.end_amdhsa_kernel
```
